```python
import torch

def _softmax(x, axis=-1):
    return torch.softmax(x, dim=axis)
def _gelu(x):
    return torch.nn.functional.gelu(x, approximate="tanh")
def _silu(x):
    return torch.nn.functional.silu(x)
def _sigmoid(x):
    return torch.sigmoid(x)
def _layernorm(x, axis=-1, eps=1e-5):
    m = x.mean(dim=axis, keepdim=True)
    v = x.var(dim=axis, keepdim=True, unbiased=False)
    return (x - m) / torch.sqrt(v + eps)
def _scatter_add(tgt, idx, src, axis=0):
    return tgt.clone().index_add_(axis, idx, src)
def _segment_sum(src, seg, n):
    out = torch.zeros((n,) + src.shape[1:], dtype=src.dtype)
    return out.index_add_(0, seg, src)
def _pad(x, pw):
    flat = tuple(v for pair in reversed(pw) for v in pair)
    return torch.nn.functional.pad(x, flat)

kernel_name = 'gated_mix__spectral_fnet__sliding_block__prompt'

def setup_inputs():

    _w = (lambda a: (lambda t: t.to(torch.bfloat16) if t.is_floating_point() else t)(torch.as_tensor(a)))
    def _A_setup():
        B, S, D = 1, 2048, 512
        ns = torch.arange(S)[:, None] * torch.arange(S)[None, :]
        nd = torch.arange(D)[:, None] * torch.arange(D)[None, :]
        Ws_re = torch.cos(-2.0 * torch.pi * ns / S).to(float)
        Ws_im = torch.sin(-2.0 * torch.pi * ns / S).to(float)
        Wd_re = torch.cos(-2.0 * torch.pi * nd / D).to(float)
        Wd_im = torch.sin(-2.0 * torch.pi * nd / D).to(float)
        return {
            "x": _w((lambda *s: torch.randn(*s, dtype=torch.bfloat16) * 0.05)(B, S, D)),
            "dft_seq_re": _w(Ws_re),
            "dft_seq_im": _w(Ws_im),
            "dft_hid_re": _w(Wd_re),
            "dft_hid_im": _w(Wd_im),
        }
    _A_in = _A_setup()

    def _B_setup():
        B, S, D = 1, 2048, 512
        return {
            "x": _w((lambda *s: torch.randn(*s, dtype=torch.bfloat16) * 0.05)(B, S, D)),
            "wqkv": _w((lambda *s: torch.randn(*s, dtype=torch.bfloat16) * 1.6)(D, 3 * D)),
            "wo": _w((lambda *s: torch.randn(*s, dtype=torch.bfloat16) * 1.6)(D, D)),
        }
    _B_in = _B_setup()

    return {
        "A_x": _A_in["x"],
        "A_dft_seq_re": _A_in["dft_seq_re"],
        "A_dft_seq_im": _A_in["dft_seq_im"],
        "A_dft_hid_re": _A_in["dft_hid_re"],
        "A_dft_hid_im": _A_in["dft_hid_im"],
        "B_x": _B_in["x"],
        "B_wqkv": _B_in["wqkv"],
        "B_wo": _B_in["wo"],
        "gate_w": _w((lambda *s: torch.randn(*s, dtype=torch.bfloat16) * 0.05)(512) * 16.0),
    }

def reference(A_x, A_dft_seq_re, A_dft_seq_im, A_dft_hid_re, A_dft_hid_im, B_x, B_wqkv, B_wo, gate_w):
    def _A_ref(x, dft_seq_re, dft_seq_im, dft_hid_re, dft_hid_im):
        a = torch.einsum("bsd,ed->bse", x, dft_hid_re)
        b = torch.einsum("bsd,ed->bse", x, dft_hid_im)
        y = torch.einsum("ts,bse->bte", dft_seq_re, a) - torch.einsum("ts,bse->bte", dft_seq_im, b)
        return y

    def _B_ref(x, wqkv, wo):
        B, S, D = x.shape
        H = 32; Dh = D // H; W = 256
        qkv = (lambda x, *d: x.permute(*d))((x @ wqkv).reshape(B, S, 3, H, Dh), 2, 0, 3, 1, 4)
        q, k, v = qkv[0], qkv[1], qkv[2]
        scores = torch.einsum("bhqd,bhkd->bhqk", q, k) * (Dh ** -0.5)
        idx = torch.arange(S)
        mask = (idx[:, None] - idx[None, :] >= 0) & (idx[:, None] - idx[None, :] < W)
        scores = torch.where(mask[None, None], scores, -1e9)
        p = _softmax(scores, axis=-1)
        o = torch.einsum("bhqk,bhkd->bhqd", p, v)
        return (lambda x, *d: x.permute(*d))(o, 0, 2, 1, 3).reshape(B, S, D) @ wo

    x = A_x
    g = _sigmoid((x * gate_w).sum(-1, keepdims=True))
    a = _A_ref(x, A_dft_seq_re, A_dft_seq_im, A_dft_hid_re, A_dft_hid_im)
    b = _B_ref(x, B_wqkv, B_wo)
    return g * a + (1 - g) * b
```

```asm
; @launch grid=(256,1,1) block=(512,1,1) lds=163840
.amdgcn_target "amdgcn-amd-amdhsa--gfx950"
.text
.globl gated_mix__spectral_fnet__sliding_block__prompt_kernel
.type gated_mix__spectral_fnet__sliding_block__prompt_kernel,@function
.p2align 12
gated_mix__spectral_fnet__sliding_block__prompt_kernel:
    s_load_dwordx16 s[16:31], s[0:1], 0
    s_load_dwordx8 s[32:39], s[0:1], 64
    s_cmp_ge_u32 s2, 256
    s_cbranch_scc1 gated_mix__spectral_fnet__sliding_block__prompt_kernel_end
    v_lshrrev_b32 v1, 6, v0
    v_and_b32 v0, 63, v0
    v_readfirstlane_b32 s3, v1
    s_getpc_b64 s[10:11]
gated_mix__spectral_fnet__sliding_block__prompt_kernel_pc:
    s_nop 2
    s_sub_u32 s9, s3, 4
    s_cmp_ge_u32 s9, 3
    s_cbranch_scc1 gated_mix__spectral_fnet__sliding_block__prompt_kernel_npf
    s_lshl_b32 s9, s9, 13
    s_sub_u32 s9, s9, gated_mix__spectral_fnet__sliding_block__prompt_kernel_pc-gated_mix__spectral_fnet__sliding_block__prompt_kernel
    v_lshl_add_u32 v4, v0, 7, s9
    v_ashrrev_i32 v5, 31, v4
    v_add_co_u32 v4, vcc, s10, v4
    v_mov_b32 v6, s11
    s_nop 0
    v_addc_co_u32 v5, vcc, v6, v5, vcc
    global_load_dword v127, v[4:5], off
gated_mix__spectral_fnet__sliding_block__prompt_kernel_npf:
    s_and_b32 s8, s2, 7
    s_lshr_b32 s9, s2, 3
    s_lshr_b32 s10, s8, 1
    s_and_b32 s11, s8, 1
    s_lshl_b32 s4, s10, 2
    s_and_b32 s12, s9, 3
    s_add_u32 s4, s4, s12
    s_lshl_b32 s5, s11, 2
    s_bfe_u32 s13, s9, 0x20002
    s_add_u32 s5, s5, s13
    s_lshr_b32 s6, s9, 4
    s_lshl_b32 s7, s5, 1
    s_add_u32 s7, s7, s6
    v_mov_b32 v8, 98048
    v_mov_b64 v[4:5], 0
    v_mov_b64 v[6:7], 0
    ds_write_b128 v8, v[4:7]
    ds_write_b128 v8, v[4:7] offset:16
    s_and_b32 s60, s3, 3
    s_lshr_b32 s66, s9, 2
    s_add_u32 s66, s66, s12
    s_and_b32 s66, s66, 3
    s_lshl_b32 s66, s66, 1
    s_lshl_b32 s64, s8, 2
    s_add_u32 s64, s64, s12
    s_lshr_b32 s65, s9, 2
    v_lshrrev_b32 v1, 3, v0
    v_and_b32 v2, 7, v0
    v_lshrrev_b32 v3, 4, v0
    v_xor_b32 v2, v2, v3
    v_lshlrev_b32 v2, 4, v2
    s_lshl_b32 s8, s4, 17
    s_lshl_b32 s10, s60, 15
    s_add_u32 s8, s8, s10
    v_lshl_add_u32 v5, v1, 10, v2
    v_add_u32 v96, s8, v5
    v_add_u32 v97, 7168, v96
    v_xor_b32 v97, 64, v97
    v_add_u32 v98, 14336, v96
    v_add_u32 v99, 14336, v97
    v_mul_u32_u24 v5, 3072, v1
    v_bfe_u32 v6, v0, 2, 1
    v_and_b32 v7, 1, v3
    v_xor_b32 v6, v6, v7
    v_lshl_add_u32 v5, v6, 6, v5
    v_and_b32 v7, 3, v0
    v_lshl_add_u32 v5, v7, 4, v5
    s_mul_i32 s8, s60, 49152
    s_lshl_b32 s10, s6, 10
    s_add_u32 s10, s10, s8
    s_lshl_b32 s11, s5, 7
    s_add_u32 s10, s10, s11
    s_add_u32 s10, s10, 1024
    v_add_u32 v100, s10, v5
    v_add_u32 v101, 23552, v100
    s_lshl_b32 s14, s60, 12
    s_lshl_b32 s67, s60, 11
    s_waitcnt lgkmcnt(0)
    s_mov_b32 s40, s16
    s_mov_b32 s41, s17
    s_mov_b32 s42, 2097152
    s_mov_b32 s43, 0x00020000
    s_mov_b32 s44, s28
    s_mov_b32 s45, s29
    s_mov_b32 s46, 1572864
    s_mov_b32 s47, 0x00020000
    s_cmp_ge_u32 s3, 4
    s_cbranch_scc1 gated_mix__spectral_fnet__sliding_block__prompt_kernel_L
    s_xor_b32 s9, s66, 0
    s_add_u32 m0, s14, 0
    s_lshl_b32 s10, s9, 7
    s_mul_i32 s11, s9, 196608
    buffer_load_dwordx4 v96, s[40:43], s10 offen offset:0 lds
    buffer_load_dwordx4 v97, s[40:43], s10 offen offset:1024 lds
    buffer_load_dwordx4 v98, s[40:43], s10 offen offset:2048 lds
    buffer_load_dwordx4 v99, s[40:43], s10 offen offset:3072 lds
    s_add_u32 m0, s67, 16384
    s_nop 0
    buffer_load_dwordx4 v100, s[44:47], s11 offen offset:0 lds
    buffer_load_dwordx4 v101, s[44:47], s11 offen offset:1024 lds
    s_xor_b32 s9, s66, 1
    s_add_u32 m0, s14, 32768
    s_lshl_b32 s10, s9, 7
    s_mul_i32 s11, s9, 196608
    buffer_load_dwordx4 v96, s[40:43], s10 offen offset:0 lds
    buffer_load_dwordx4 v97, s[40:43], s10 offen offset:1024 lds
    buffer_load_dwordx4 v98, s[40:43], s10 offen offset:2048 lds
    buffer_load_dwordx4 v99, s[40:43], s10 offen offset:3072 lds
    s_add_u32 m0, s67, 49152
    s_nop 0
    buffer_load_dwordx4 v100, s[44:47], s11 offen offset:0 lds
    buffer_load_dwordx4 v101, s[44:47], s11 offen offset:1024 lds
gated_mix__spectral_fnet__sliding_block__prompt_kernel_comp:
    v_and_b32 v1, 31, v0
    v_lshrrev_b32 v2, 5, v0
    v_bfe_u32 v3, v0, 1, 3
    v_xor_b32 v3, v3, v2
    v_lshlrev_b32 v3, 4, v3
    v_lshl_add_u32 v3, v1, 7, v3
    s_lshl_b32 s9, s3, 12
    v_add_u32 v8, s9, v3
    v_xor_b32 v9, 32, v8
    v_xor_b32 v10, 64, v8
    v_xor_b32 v11, 96, v8
    v_bfe_u32 v4, v0, 2, 2
    v_lshl_add_u32 v5, v2, 3, v4
    v_bfe_u32 v6, v0, 4, 1
    v_lshlrev_b32 v6, 5, v6
    v_and_b32 v7, 3, v0
    v_lshl_add_u32 v6, v7, 3, v6
    v_lshl_add_u32 v14, v5, 6, v6
    v_add_u32 v14, 98304, v14
    v_lshl_add_u32 v5, v5, 7, v6
    v_lshrrev_b32 v4, 1, v4
    v_lshl_add_u32 v12, v4, 6, v5
    v_xor_b32 v13, 64, v12
    v_mov_b32 v28, 98048
    v_mov_b32 v29, 1
    s_waitcnt lgkmcnt(0)
    s_mov_b32 s48, s38
    s_mov_b32 s49, s39
    s_mov_b32 s50, 16777216
    s_mov_b32 s51, 0x00020000
    s_mov_b32 s56, s36
    s_mov_b32 s57, s37
    s_mov_b32 s58, 256
    s_mov_b32 s59, 0x00020000
    s_lshl_b32 s8, s5, 7
    s_lshl_b32 s9, s4, 2
    s_add_u32 s8, s8, s9
    s_add_u32 s8, s8, s3
    s_lshl_b32 s8, s8, 12
    s_lshl_b32 s9, s6, 11
    s_add_u32 s8, s8, s9
    s_add_u32 s60, s8, 262144
    s_lshl_b32 s77, s4, 4
    s_add_u32 s77, s77, s7
    s_lshl_b32 s77, s77, 2
    s_add_u32 s77, s77, s3
    s_lshl_b32 s77, s77, 8
    s_add_u32 s77, s77, 11010048
    v_lshlrev_b32 v15, 4, v0
    s_mul_i32 s66, s3, 3
    s_lshl_b32 s67, s4, 2
    s_add_u32 s66, s66, s67
    s_sub_u32 s66, s66, 8
    v_lshrrev_b32 v4, 1, v0
    v_add_u32 v4, s66, v4
    v_ashrrev_i32 v5, 31, v4
    v_mov_b32 v6, s67
    v_bfi_b32 v4, v5, v6, v4
    v_lshrrev_b32 v5, 2, v4
    v_lshlrev_b32 v5, 6, v5
    v_and_b32 v6, 3, v4
    v_and_b32 v7, 1, v0
    v_lshl_add_u32 v6, v7, 2, v6
    s_lshl_b32 s11, s5, 3
    v_add3_u32 v5, v5, v6, s11
    v_lshlrev_b32 v18, 8, v5
    s_cmp_eq_u32 s6, 1
    s_cbranch_scc1 gated_mix__spectral_fnet__sliding_block__prompt_kernel_V
    s_barrier
    s_waitcnt vmcnt(6)
    s_mov_b64 exec, 1
    ds_add_u32 v28, v29 offset:24
    s_mov_b64 exec, -1
lw5:
    ds_read_b32 v30, v28 offset:24
    s_waitcnt lgkmcnt(0)
    v_readfirstlane_b32 s78, v30
    s_cmp_lt_u32 s78, 4
    s_cbranch_scc1 lw5
    ds_read_b128 v[128:131], v8
    ds_read_b64_tr_b16 v[96:97], v12 offset:16384
    ds_read_b64_tr_b16 v[98:99], v12 offset:16896
    ds_read_b64_tr_b16 v[100:101], v13 offset:16384
    ds_read_b64_tr_b16 v[102:103], v13 offset:16896
    ds_read_b128 v[132:135], v9
    ds_read_b64_tr_b16 v[104:105], v12 offset:18432
    ds_read_b64_tr_b16 v[106:107], v12 offset:18944
    ds_read_b64_tr_b16 v[108:109], v13 offset:18432
    ds_read_b64_tr_b16 v[110:111], v13 offset:18944
    s_waitcnt lgkmcnt(5)
    v_mfma_f32_32x32x16_bf16 v[64:79], v[96:99], v[128:131], 0
    ds_read_b128 v[136:139], v10
    ds_read_b64_tr_b16 v[112:113], v12 offset:20480
    ds_read_b64_tr_b16 v[114:115], v12 offset:20992
    v_mfma_f32_32x32x16_bf16 v[80:95], v[100:103], v[128:131], 0
    ds_read_b64_tr_b16 v[116:117], v13 offset:20480
    ds_read_b64_tr_b16 v[118:119], v13 offset:20992
    s_waitcnt lgkmcnt(5)
    v_mfma_f32_32x32x16_bf16 v[64:79], v[104:107], v[132:135], v[64:79]
    ds_read_b128 v[140:143], v11
    ds_read_b64_tr_b16 v[120:121], v12 offset:22528
    ds_read_b64_tr_b16 v[122:123], v12 offset:23040
    v_mfma_f32_32x32x16_bf16 v[80:95], v[108:111], v[132:135], v[80:95]
    ds_read_b64_tr_b16 v[124:125], v13 offset:22528
    ds_read_b64_tr_b16 v[126:127], v13 offset:23040
    s_waitcnt lgkmcnt(5)
    v_mfma_f32_32x32x16_bf16 v[64:79], v[112:115], v[136:139], v[64:79]
    v_add_u32 v8, 32768, v8
    v_add_u32 v9, 32768, v9
    v_add_u32 v10, 32768, v10
    v_add_u32 v11, 32768, v11
    v_add_u32 v12, 32768, v12
    v_add_u32 v13, 32768, v13
    s_waitcnt vmcnt(0)
    s_mov_b64 exec, 1
    ds_add_u32 v28, v29 offset:24
    s_mov_b64 exec, -1
lw6:
    ds_read_b32 v30, v28 offset:24
    s_waitcnt lgkmcnt(0)
    v_readfirstlane_b32 s78, v30
    s_cmp_lt_u32 s78, 8
    s_cbranch_scc1 lw6
    ds_read_b128 v[144:147], v8
    ds_read_b64_tr_b16 v[96:97], v12 offset:16384
    ds_read_b64_tr_b16 v[98:99], v12 offset:16896
    v_mfma_f32_32x32x16_bf16 v[80:95], v[116:119], v[136:139], v[80:95]
    ds_read_b64_tr_b16 v[100:101], v13 offset:16384
    ds_read_b64_tr_b16 v[102:103], v13 offset:16896
    s_waitcnt lgkmcnt(5)
    v_mfma_f32_32x32x16_bf16 v[64:79], v[120:123], v[140:143], v[64:79]
    ds_read_b128 v[148:151], v9
    ds_read_b64_tr_b16 v[104:105], v12 offset:18432
    ds_read_b64_tr_b16 v[106:107], v12 offset:18944
    v_mfma_f32_32x32x16_bf16 v[80:95], v[124:127], v[140:143], v[80:95]
    ds_read_b64_tr_b16 v[108:109], v13 offset:18432
    ds_read_b64_tr_b16 v[110:111], v13 offset:18944
    s_waitcnt lgkmcnt(5)
    v_mfma_f32_32x32x16_bf16 v[64:79], v[96:99], v[144:147], v[64:79]
    ds_read_b128 v[152:155], v10
    ds_read_b64_tr_b16 v[112:113], v12 offset:20480
    ds_read_b64_tr_b16 v[114:115], v12 offset:20992
    v_mfma_f32_32x32x16_bf16 v[80:95], v[100:103], v[144:147], v[80:95]
    ds_read_b64_tr_b16 v[116:117], v13 offset:20480
    ds_read_b64_tr_b16 v[118:119], v13 offset:20992
    s_waitcnt lgkmcnt(5)
    v_mfma_f32_32x32x16_bf16 v[64:79], v[104:107], v[148:151], v[64:79]
    ds_read_b128 v[156:159], v11
    ds_read_b64_tr_b16 v[120:121], v12 offset:22528
    ds_read_b64_tr_b16 v[122:123], v12 offset:23040
    v_mfma_f32_32x32x16_bf16 v[80:95], v[108:111], v[148:151], v[80:95]
    ds_read_b64_tr_b16 v[124:125], v13 offset:22528
    ds_read_b64_tr_b16 v[126:127], v13 offset:23040
    s_waitcnt lgkmcnt(5)
    v_mfma_f32_32x32x16_bf16 v[64:79], v[112:115], v[152:155], v[64:79]
    v_add_u32 v8, 32768, v8
    v_add_u32 v9, 32768, v9
    v_add_u32 v10, 32768, v10
    v_add_u32 v11, 32768, v11
    v_add_u32 v12, 32768, v12
    v_add_u32 v13, 32768, v13
    s_barrier
    ds_read_b128 v[160:163], v8
    ds_read_b64_tr_b16 v[96:97], v12 offset:16384
    ds_read_b64_tr_b16 v[98:99], v12 offset:16896
    v_mfma_f32_32x32x16_bf16 v[80:95], v[116:119], v[152:155], v[80:95]
    ds_read_b64_tr_b16 v[100:101], v13 offset:16384
    ds_read_b64_tr_b16 v[102:103], v13 offset:16896
    s_waitcnt lgkmcnt(5)
    v_mfma_f32_32x32x16_bf16 v[64:79], v[120:123], v[156:159], v[64:79]
    ds_read_b128 v[164:167], v9
    ds_read_b64_tr_b16 v[104:105], v12 offset:18432
    ds_read_b64_tr_b16 v[106:107], v12 offset:18944
    v_mfma_f32_32x32x16_bf16 v[80:95], v[124:127], v[156:159], v[80:95]
    ds_read_b64_tr_b16 v[108:109], v13 offset:18432
    ds_read_b64_tr_b16 v[110:111], v13 offset:18944
    s_waitcnt lgkmcnt(5)
    v_mfma_f32_32x32x16_bf16 v[64:79], v[96:99], v[160:163], v[64:79]
    ds_read_b128 v[168:171], v10
    ds_read_b64_tr_b16 v[112:113], v12 offset:20480
    ds_read_b64_tr_b16 v[114:115], v12 offset:20992
    v_mfma_f32_32x32x16_bf16 v[80:95], v[100:103], v[160:163], v[80:95]
    ds_read_b64_tr_b16 v[116:117], v13 offset:20480
    ds_read_b64_tr_b16 v[118:119], v13 offset:20992
    s_waitcnt lgkmcnt(5)
    v_mfma_f32_32x32x16_bf16 v[64:79], v[104:107], v[164:167], v[64:79]
    ds_read_b128 v[172:175], v11
    ds_read_b64_tr_b16 v[120:121], v12 offset:22528
    ds_read_b64_tr_b16 v[122:123], v12 offset:23040
    v_mfma_f32_32x32x16_bf16 v[80:95], v[108:111], v[164:167], v[80:95]
    ds_read_b64_tr_b16 v[124:125], v13 offset:22528
    ds_read_b64_tr_b16 v[126:127], v13 offset:23040
    s_waitcnt lgkmcnt(5)
    v_mfma_f32_32x32x16_bf16 v[64:79], v[112:115], v[168:171], v[64:79]
    v_add_u32 v8, 32768, v8
    v_add_u32 v9, 32768, v9
    v_add_u32 v10, 32768, v10
    v_add_u32 v11, 32768, v11
    v_add_u32 v12, 32768, v12
    v_add_u32 v13, 32768, v13
    s_barrier
    ds_read_b128 v[176:179], v8
    ds_read_b64_tr_b16 v[96:97], v12 offset:16384
    ds_read_b64_tr_b16 v[98:99], v12 offset:16896
    v_mfma_f32_32x32x16_bf16 v[80:95], v[116:119], v[168:171], v[80:95]
    ds_read_b64_tr_b16 v[100:101], v13 offset:16384
    ds_read_b64_tr_b16 v[102:103], v13 offset:16896
    s_waitcnt lgkmcnt(5)
    v_mfma_f32_32x32x16_bf16 v[64:79], v[120:123], v[172:175], v[64:79]
    ds_read_b128 v[180:183], v9
    ds_read_b64_tr_b16 v[104:105], v12 offset:18432
    ds_read_b64_tr_b16 v[106:107], v12 offset:18944
    v_mfma_f32_32x32x16_bf16 v[80:95], v[124:127], v[172:175], v[80:95]
    ds_read_b64_tr_b16 v[108:109], v13 offset:18432
    ds_read_b64_tr_b16 v[110:111], v13 offset:18944
    s_waitcnt lgkmcnt(5)
    v_mfma_f32_32x32x16_bf16 v[64:79], v[96:99], v[176:179], v[64:79]
    ds_read_b128 v[184:187], v10
    ds_read_b64_tr_b16 v[112:113], v12 offset:20480
    ds_read_b64_tr_b16 v[114:115], v12 offset:20992
    v_mfma_f32_32x32x16_bf16 v[80:95], v[100:103], v[176:179], v[80:95]
    ds_read_b64_tr_b16 v[116:117], v13 offset:20480
    ds_read_b64_tr_b16 v[118:119], v13 offset:20992
    s_waitcnt lgkmcnt(5)
    v_mfma_f32_32x32x16_bf16 v[64:79], v[104:107], v[180:183], v[64:79]
    ds_read_b128 v[188:191], v11
    ds_read_b64_tr_b16 v[120:121], v12 offset:22528
    ds_read_b64_tr_b16 v[122:123], v12 offset:23040
    v_mfma_f32_32x32x16_bf16 v[80:95], v[108:111], v[180:183], v[80:95]
    ds_read_b64_tr_b16 v[124:125], v13 offset:22528
    ds_read_b64_tr_b16 v[126:127], v13 offset:23040
    s_waitcnt lgkmcnt(5)
    v_mfma_f32_32x32x16_bf16 v[64:79], v[112:115], v[184:187], v[64:79]
    v_add_u32 v8, 32768, v8
    v_add_u32 v9, 32768, v9
    v_add_u32 v10, 32768, v10
    v_add_u32 v11, 32768, v11
    v_add_u32 v12, 32768, v12
    v_add_u32 v13, 32768, v13
    s_barrier
    ds_read_b128 v[192:195], v8
    ds_read_b64_tr_b16 v[96:97], v12 offset:16384
    ds_read_b64_tr_b16 v[98:99], v12 offset:16896
    v_mfma_f32_32x32x16_bf16 v[80:95], v[116:119], v[184:187], v[80:95]
    ds_read_b64_tr_b16 v[100:101], v13 offset:16384
    ds_read_b64_tr_b16 v[102:103], v13 offset:16896
    s_waitcnt lgkmcnt(5)
    v_mfma_f32_32x32x16_bf16 v[64:79], v[120:123], v[188:191], v[64:79]
    ds_read_b128 v[196:199], v9
    ds_read_b64_tr_b16 v[104:105], v12 offset:18432
    ds_read_b64_tr_b16 v[106:107], v12 offset:18944
    v_mfma_f32_32x32x16_bf16 v[80:95], v[124:127], v[188:191], v[80:95]
    ds_read_b64_tr_b16 v[108:109], v13 offset:18432
    ds_read_b64_tr_b16 v[110:111], v13 offset:18944
    s_waitcnt lgkmcnt(5)
    v_mfma_f32_32x32x16_bf16 v[64:79], v[96:99], v[192:195], v[64:79]
    ds_read_b128 v[200:203], v10
    ds_read_b64_tr_b16 v[112:113], v12 offset:20480
    ds_read_b64_tr_b16 v[114:115], v12 offset:20992
    v_mfma_f32_32x32x16_bf16 v[80:95], v[100:103], v[192:195], v[80:95]
    ds_read_b64_tr_b16 v[116:117], v13 offset:20480
    ds_read_b64_tr_b16 v[118:119], v13 offset:20992
    s_waitcnt lgkmcnt(5)
    v_mfma_f32_32x32x16_bf16 v[64:79], v[104:107], v[196:199], v[64:79]
    ds_read_b128 v[204:207], v11
    ds_read_b64_tr_b16 v[120:121], v12 offset:22528
    ds_read_b64_tr_b16 v[122:123], v12 offset:23040
    v_mfma_f32_32x32x16_bf16 v[80:95], v[108:111], v[196:199], v[80:95]
    ds_read_b64_tr_b16 v[124:125], v13 offset:22528
    ds_read_b64_tr_b16 v[126:127], v13 offset:23040
    s_waitcnt lgkmcnt(5)
    v_mfma_f32_32x32x16_bf16 v[64:79], v[112:115], v[200:203], v[64:79]
    v_subrev_u32 v8, 131072, v8
    v_subrev_u32 v9, 131072, v9
    v_subrev_u32 v10, 131072, v10
    v_subrev_u32 v11, 131072, v11
    v_subrev_u32 v12, 131072, v12
    v_subrev_u32 v13, 131072, v13
    s_barrier
    ds_read_b128 v[208:211], v8
    ds_read_b64_tr_b16 v[96:97], v12 offset:16384
    ds_read_b64_tr_b16 v[98:99], v12 offset:16896
    v_mfma_f32_32x32x16_bf16 v[80:95], v[116:119], v[200:203], v[80:95]
    ds_read_b64_tr_b16 v[100:101], v13 offset:16384
    ds_read_b64_tr_b16 v[102:103], v13 offset:16896
    s_waitcnt lgkmcnt(5)
    v_mfma_f32_32x32x16_bf16 v[64:79], v[120:123], v[204:207], v[64:79]
    ds_read_b128 v[212:215], v9
    ds_read_b64_tr_b16 v[104:105], v12 offset:18432
    ds_read_b64_tr_b16 v[106:107], v12 offset:18944
    v_mfma_f32_32x32x16_bf16 v[80:95], v[124:127], v[204:207], v[80:95]
    ds_read_b64_tr_b16 v[108:109], v13 offset:18432
    ds_read_b64_tr_b16 v[110:111], v13 offset:18944
    s_waitcnt lgkmcnt(5)
    v_mfma_f32_32x32x16_bf16 v[64:79], v[96:99], v[208:211], v[64:79]
    ds_read_b128 v[216:219], v10
    ds_read_b64_tr_b16 v[112:113], v12 offset:20480
    ds_read_b64_tr_b16 v[114:115], v12 offset:20992
    v_mfma_f32_32x32x16_bf16 v[80:95], v[100:103], v[208:211], v[80:95]
    ds_read_b64_tr_b16 v[116:117], v13 offset:20480
    ds_read_b64_tr_b16 v[118:119], v13 offset:20992
    s_waitcnt lgkmcnt(5)
    v_mfma_f32_32x32x16_bf16 v[64:79], v[104:107], v[212:215], v[64:79]
    ds_read_b128 v[220:223], v11
    ds_read_b64_tr_b16 v[120:121], v12 offset:22528
    ds_read_b64_tr_b16 v[122:123], v12 offset:23040
    v_mfma_f32_32x32x16_bf16 v[80:95], v[108:111], v[212:215], v[80:95]
    ds_read_b64_tr_b16 v[124:125], v13 offset:22528
    ds_read_b64_tr_b16 v[126:127], v13 offset:23040
    s_waitcnt lgkmcnt(5)
    v_mfma_f32_32x32x16_bf16 v[64:79], v[112:115], v[216:219], v[64:79]
    v_add_u32 v8, 32768, v8
    v_add_u32 v9, 32768, v9
    v_add_u32 v10, 32768, v10
    v_add_u32 v11, 32768, v11
    v_add_u32 v12, 32768, v12
    v_add_u32 v13, 32768, v13
    buffer_load_dword v16, off, s[56:59], 0 sc1
    s_barrier
    ds_read_b128 v[224:227], v8
    ds_read_b64_tr_b16 v[96:97], v12 offset:16384
    ds_read_b64_tr_b16 v[98:99], v12 offset:16896
    v_mfma_f32_32x32x16_bf16 v[80:95], v[116:119], v[216:219], v[80:95]
    ds_read_b64_tr_b16 v[100:101], v13 offset:16384
    ds_read_b64_tr_b16 v[102:103], v13 offset:16896
    s_waitcnt lgkmcnt(5)
    v_mfma_f32_32x32x16_bf16 v[64:79], v[120:123], v[220:223], v[64:79]
    ds_read_b128 v[228:231], v9
    ds_read_b64_tr_b16 v[104:105], v12 offset:18432
    ds_read_b64_tr_b16 v[106:107], v12 offset:18944
    v_mfma_f32_32x32x16_bf16 v[80:95], v[124:127], v[220:223], v[80:95]
    ds_read_b64_tr_b16 v[108:109], v13 offset:18432
    ds_read_b64_tr_b16 v[110:111], v13 offset:18944
    s_waitcnt lgkmcnt(5)
    v_mfma_f32_32x32x16_bf16 v[64:79], v[96:99], v[224:227], v[64:79]
    ds_read_b128 v[232:235], v10
    ds_read_b64_tr_b16 v[112:113], v12 offset:20480
    ds_read_b64_tr_b16 v[114:115], v12 offset:20992
    v_mfma_f32_32x32x16_bf16 v[80:95], v[100:103], v[224:227], v[80:95]
    ds_read_b64_tr_b16 v[116:117], v13 offset:20480
    ds_read_b64_tr_b16 v[118:119], v13 offset:20992
    s_waitcnt lgkmcnt(5)
    v_mfma_f32_32x32x16_bf16 v[64:79], v[104:107], v[228:231], v[64:79]
    ds_read_b128 v[236:239], v11
    ds_read_b64_tr_b16 v[120:121], v12 offset:22528
    ds_read_b64_tr_b16 v[122:123], v12 offset:23040
    v_mfma_f32_32x32x16_bf16 v[80:95], v[108:111], v[228:231], v[80:95]
    ds_read_b64_tr_b16 v[124:125], v13 offset:22528
    ds_read_b64_tr_b16 v[126:127], v13 offset:23040
    s_waitcnt lgkmcnt(5)
    v_mfma_f32_32x32x16_bf16 v[64:79], v[112:115], v[232:235], v[64:79]
    v_add_u32 v8, 32768, v8
    v_add_u32 v9, 32768, v9
    v_add_u32 v10, 32768, v10
    v_add_u32 v11, 32768, v11
    v_add_u32 v12, 32768, v12
    v_add_u32 v13, 32768, v13
    ds_read_b128 v[240:243], v8
    ds_read_b64_tr_b16 v[96:97], v12 offset:16384
    ds_read_b64_tr_b16 v[98:99], v12 offset:16896
    v_mfma_f32_32x32x16_bf16 v[80:95], v[116:119], v[232:235], v[80:95]
    ds_read_b64_tr_b16 v[100:101], v13 offset:16384
    ds_read_b64_tr_b16 v[102:103], v13 offset:16896
    s_waitcnt lgkmcnt(5)
    v_mfma_f32_32x32x16_bf16 v[64:79], v[120:123], v[236:239], v[64:79]
    ds_read_b128 v[244:247], v9
    ds_read_b64_tr_b16 v[104:105], v12 offset:18432
    ds_read_b64_tr_b16 v[106:107], v12 offset:18944
    v_mfma_f32_32x32x16_bf16 v[80:95], v[124:127], v[236:239], v[80:95]
    ds_read_b64_tr_b16 v[108:109], v13 offset:18432
    ds_read_b64_tr_b16 v[110:111], v13 offset:18944
    s_waitcnt lgkmcnt(5)
    v_mfma_f32_32x32x16_bf16 v[64:79], v[96:99], v[240:243], v[64:79]
    ds_read_b128 v[248:251], v10
    ds_read_b64_tr_b16 v[112:113], v12 offset:20480
    ds_read_b64_tr_b16 v[114:115], v12 offset:20992
    v_mfma_f32_32x32x16_bf16 v[80:95], v[100:103], v[240:243], v[80:95]
    ds_read_b64_tr_b16 v[116:117], v13 offset:20480
    ds_read_b64_tr_b16 v[118:119], v13 offset:20992
    s_waitcnt lgkmcnt(5)
    v_mfma_f32_32x32x16_bf16 v[64:79], v[104:107], v[244:247], v[64:79]
    ds_read_b128 v[252:255], v11
    ds_read_b64_tr_b16 v[120:121], v12 offset:22528
    ds_read_b64_tr_b16 v[122:123], v12 offset:23040
    v_mfma_f32_32x32x16_bf16 v[80:95], v[108:111], v[244:247], v[80:95]
    ds_read_b64_tr_b16 v[124:125], v13 offset:22528
    ds_read_b64_tr_b16 v[126:127], v13 offset:23040
    s_waitcnt lgkmcnt(5)
    v_mfma_f32_32x32x16_bf16 v[64:79], v[112:115], v[248:251], v[64:79]
    v_mfma_f32_32x32x16_bf16 v[80:95], v[116:119], v[248:251], v[80:95]
    s_waitcnt lgkmcnt(0)
    v_mfma_f32_32x32x16_bf16 v[64:79], v[120:123], v[252:255], v[64:79]
    v_mfma_f32_32x32x16_bf16 v[80:95], v[124:127], v[252:255], v[80:95]
    s_branch gated_mix__spectral_fnet__sliding_block__prompt_kernel_p1d
gated_mix__spectral_fnet__sliding_block__prompt_kernel_V:
    s_barrier
    s_waitcnt vmcnt(6)
    s_mov_b64 exec, 1
    ds_add_u32 v28, v29 offset:24
    s_mov_b64 exec, -1
lw7:
    ds_read_b32 v30, v28 offset:24
    s_waitcnt lgkmcnt(0)
    v_readfirstlane_b32 s78, v30
    s_cmp_lt_u32 s78, 4
    s_cbranch_scc1 lw7
    ds_read_b128 v[128:131], v8
    ds_read_b64_tr_b16 v[96:97], v12 offset:16384
    ds_read_b64_tr_b16 v[98:99], v12 offset:16896
    ds_read_b64_tr_b16 v[100:101], v13 offset:16384
    ds_read_b64_tr_b16 v[102:103], v13 offset:16896
    ds_read_b128 v[132:135], v9
    ds_read_b64_tr_b16 v[104:105], v12 offset:18432
    ds_read_b64_tr_b16 v[106:107], v12 offset:18944
    ds_read_b64_tr_b16 v[108:109], v13 offset:18432
    ds_read_b64_tr_b16 v[110:111], v13 offset:18944
    s_waitcnt lgkmcnt(5)
    v_mfma_f32_32x32x16_bf16 v[64:79], v[128:131], v[96:99], 0
    ds_read_b128 v[136:139], v10
    ds_read_b64_tr_b16 v[112:113], v12 offset:20480
    ds_read_b64_tr_b16 v[114:115], v12 offset:20992
    v_mfma_f32_32x32x16_bf16 v[80:95], v[128:131], v[100:103], 0
    ds_read_b64_tr_b16 v[116:117], v13 offset:20480
    ds_read_b64_tr_b16 v[118:119], v13 offset:20992
    s_waitcnt lgkmcnt(5)
    v_mfma_f32_32x32x16_bf16 v[64:79], v[132:135], v[104:107], v[64:79]
    ds_read_b128 v[140:143], v11
    ds_read_b64_tr_b16 v[120:121], v12 offset:22528
    ds_read_b64_tr_b16 v[122:123], v12 offset:23040
    v_mfma_f32_32x32x16_bf16 v[80:95], v[132:135], v[108:111], v[80:95]
    ds_read_b64_tr_b16 v[124:125], v13 offset:22528
    ds_read_b64_tr_b16 v[126:127], v13 offset:23040
    s_waitcnt lgkmcnt(5)
    v_mfma_f32_32x32x16_bf16 v[64:79], v[136:139], v[112:115], v[64:79]
    v_add_u32 v8, 32768, v8
    v_add_u32 v9, 32768, v9
    v_add_u32 v10, 32768, v10
    v_add_u32 v11, 32768, v11
    v_add_u32 v12, 32768, v12
    v_add_u32 v13, 32768, v13
    s_waitcnt vmcnt(0)
    s_mov_b64 exec, 1
    ds_add_u32 v28, v29 offset:24
    s_mov_b64 exec, -1
lw8:
    ds_read_b32 v30, v28 offset:24
    s_waitcnt lgkmcnt(0)
    v_readfirstlane_b32 s78, v30
    s_cmp_lt_u32 s78, 8
    s_cbranch_scc1 lw8
    ds_read_b128 v[144:147], v8
    ds_read_b64_tr_b16 v[96:97], v12 offset:16384
    ds_read_b64_tr_b16 v[98:99], v12 offset:16896
    v_mfma_f32_32x32x16_bf16 v[80:95], v[136:139], v[116:119], v[80:95]
    ds_read_b64_tr_b16 v[100:101], v13 offset:16384
    ds_read_b64_tr_b16 v[102:103], v13 offset:16896
    s_waitcnt lgkmcnt(5)
    v_mfma_f32_32x32x16_bf16 v[64:79], v[140:143], v[120:123], v[64:79]
    ds_read_b128 v[148:151], v9
    ds_read_b64_tr_b16 v[104:105], v12 offset:18432
    ds_read_b64_tr_b16 v[106:107], v12 offset:18944
    v_mfma_f32_32x32x16_bf16 v[80:95], v[140:143], v[124:127], v[80:95]
    ds_read_b64_tr_b16 v[108:109], v13 offset:18432
    ds_read_b64_tr_b16 v[110:111], v13 offset:18944
    s_waitcnt lgkmcnt(5)
    v_mfma_f32_32x32x16_bf16 v[64:79], v[144:147], v[96:99], v[64:79]
    ds_read_b128 v[152:155], v10
    ds_read_b64_tr_b16 v[112:113], v12 offset:20480
    ds_read_b64_tr_b16 v[114:115], v12 offset:20992
    v_mfma_f32_32x32x16_bf16 v[80:95], v[144:147], v[100:103], v[80:95]
    ds_read_b64_tr_b16 v[116:117], v13 offset:20480
    ds_read_b64_tr_b16 v[118:119], v13 offset:20992
    s_waitcnt lgkmcnt(5)
    v_mfma_f32_32x32x16_bf16 v[64:79], v[148:151], v[104:107], v[64:79]
    ds_read_b128 v[156:159], v11
    ds_read_b64_tr_b16 v[120:121], v12 offset:22528
    ds_read_b64_tr_b16 v[122:123], v12 offset:23040
    v_mfma_f32_32x32x16_bf16 v[80:95], v[148:151], v[108:111], v[80:95]
    ds_read_b64_tr_b16 v[124:125], v13 offset:22528
    ds_read_b64_tr_b16 v[126:127], v13 offset:23040
    s_waitcnt lgkmcnt(5)
    v_mfma_f32_32x32x16_bf16 v[64:79], v[152:155], v[112:115], v[64:79]
    v_add_u32 v8, 32768, v8
    v_add_u32 v9, 32768, v9
    v_add_u32 v10, 32768, v10
    v_add_u32 v11, 32768, v11
    v_add_u32 v12, 32768, v12
    v_add_u32 v13, 32768, v13
    s_barrier
    ds_read_b128 v[160:163], v8
    ds_read_b64_tr_b16 v[96:97], v12 offset:16384
    ds_read_b64_tr_b16 v[98:99], v12 offset:16896
    v_mfma_f32_32x32x16_bf16 v[80:95], v[152:155], v[116:119], v[80:95]
    ds_read_b64_tr_b16 v[100:101], v13 offset:16384
    ds_read_b64_tr_b16 v[102:103], v13 offset:16896
    s_waitcnt lgkmcnt(5)
    v_mfma_f32_32x32x16_bf16 v[64:79], v[156:159], v[120:123], v[64:79]
    ds_read_b128 v[164:167], v9
    ds_read_b64_tr_b16 v[104:105], v12 offset:18432
    ds_read_b64_tr_b16 v[106:107], v12 offset:18944
    v_mfma_f32_32x32x16_bf16 v[80:95], v[156:159], v[124:127], v[80:95]
    ds_read_b64_tr_b16 v[108:109], v13 offset:18432
    ds_read_b64_tr_b16 v[110:111], v13 offset:18944
    s_waitcnt lgkmcnt(5)
    v_mfma_f32_32x32x16_bf16 v[64:79], v[160:163], v[96:99], v[64:79]
    ds_read_b128 v[168:171], v10
    ds_read_b64_tr_b16 v[112:113], v12 offset:20480
    ds_read_b64_tr_b16 v[114:115], v12 offset:20992
    v_mfma_f32_32x32x16_bf16 v[80:95], v[160:163], v[100:103], v[80:95]
    ds_read_b64_tr_b16 v[116:117], v13 offset:20480
    ds_read_b64_tr_b16 v[118:119], v13 offset:20992
    s_waitcnt lgkmcnt(5)
    v_mfma_f32_32x32x16_bf16 v[64:79], v[164:167], v[104:107], v[64:79]
    ds_read_b128 v[172:175], v11
    ds_read_b64_tr_b16 v[120:121], v12 offset:22528
    ds_read_b64_tr_b16 v[122:123], v12 offset:23040
    v_mfma_f32_32x32x16_bf16 v[80:95], v[164:167], v[108:111], v[80:95]
    ds_read_b64_tr_b16 v[124:125], v13 offset:22528
    ds_read_b64_tr_b16 v[126:127], v13 offset:23040
    s_waitcnt lgkmcnt(5)
    v_mfma_f32_32x32x16_bf16 v[64:79], v[168:171], v[112:115], v[64:79]
    v_add_u32 v8, 32768, v8
    v_add_u32 v9, 32768, v9
    v_add_u32 v10, 32768, v10
    v_add_u32 v11, 32768, v11
    v_add_u32 v12, 32768, v12
    v_add_u32 v13, 32768, v13
    s_barrier
    ds_read_b128 v[176:179], v8
    ds_read_b64_tr_b16 v[96:97], v12 offset:16384
    ds_read_b64_tr_b16 v[98:99], v12 offset:16896
    v_mfma_f32_32x32x16_bf16 v[80:95], v[168:171], v[116:119], v[80:95]
    ds_read_b64_tr_b16 v[100:101], v13 offset:16384
    ds_read_b64_tr_b16 v[102:103], v13 offset:16896
    s_waitcnt lgkmcnt(5)
    v_mfma_f32_32x32x16_bf16 v[64:79], v[172:175], v[120:123], v[64:79]
    ds_read_b128 v[180:183], v9
    ds_read_b64_tr_b16 v[104:105], v12 offset:18432
    ds_read_b64_tr_b16 v[106:107], v12 offset:18944
    v_mfma_f32_32x32x16_bf16 v[80:95], v[172:175], v[124:127], v[80:95]
    ds_read_b64_tr_b16 v[108:109], v13 offset:18432
    ds_read_b64_tr_b16 v[110:111], v13 offset:18944
    s_waitcnt lgkmcnt(5)
    v_mfma_f32_32x32x16_bf16 v[64:79], v[176:179], v[96:99], v[64:79]
    ds_read_b128 v[184:187], v10
    ds_read_b64_tr_b16 v[112:113], v12 offset:20480
    ds_read_b64_tr_b16 v[114:115], v12 offset:20992
    v_mfma_f32_32x32x16_bf16 v[80:95], v[176:179], v[100:103], v[80:95]
    ds_read_b64_tr_b16 v[116:117], v13 offset:20480
    ds_read_b64_tr_b16 v[118:119], v13 offset:20992
    s_waitcnt lgkmcnt(5)
    v_mfma_f32_32x32x16_bf16 v[64:79], v[180:183], v[104:107], v[64:79]
    ds_read_b128 v[188:191], v11
    ds_read_b64_tr_b16 v[120:121], v12 offset:22528
    ds_read_b64_tr_b16 v[122:123], v12 offset:23040
    v_mfma_f32_32x32x16_bf16 v[80:95], v[180:183], v[108:111], v[80:95]
    ds_read_b64_tr_b16 v[124:125], v13 offset:22528
    ds_read_b64_tr_b16 v[126:127], v13 offset:23040
    s_waitcnt lgkmcnt(5)
    v_mfma_f32_32x32x16_bf16 v[64:79], v[184:187], v[112:115], v[64:79]
    v_add_u32 v8, 32768, v8
    v_add_u32 v9, 32768, v9
    v_add_u32 v10, 32768, v10
    v_add_u32 v11, 32768, v11
    v_add_u32 v12, 32768, v12
    v_add_u32 v13, 32768, v13
    s_barrier
    ds_read_b128 v[192:195], v8
    ds_read_b64_tr_b16 v[96:97], v12 offset:16384
    ds_read_b64_tr_b16 v[98:99], v12 offset:16896
    v_mfma_f32_32x32x16_bf16 v[80:95], v[184:187], v[116:119], v[80:95]
    ds_read_b64_tr_b16 v[100:101], v13 offset:16384
    ds_read_b64_tr_b16 v[102:103], v13 offset:16896
    s_waitcnt lgkmcnt(5)
    v_mfma_f32_32x32x16_bf16 v[64:79], v[188:191], v[120:123], v[64:79]
    ds_read_b128 v[196:199], v9
    ds_read_b64_tr_b16 v[104:105], v12 offset:18432
    ds_read_b64_tr_b16 v[106:107], v12 offset:18944
    v_mfma_f32_32x32x16_bf16 v[80:95], v[188:191], v[124:127], v[80:95]
    ds_read_b64_tr_b16 v[108:109], v13 offset:18432
    ds_read_b64_tr_b16 v[110:111], v13 offset:18944
    s_waitcnt lgkmcnt(5)
    v_mfma_f32_32x32x16_bf16 v[64:79], v[192:195], v[96:99], v[64:79]
    ds_read_b128 v[200:203], v10
    ds_read_b64_tr_b16 v[112:113], v12 offset:20480
    ds_read_b64_tr_b16 v[114:115], v12 offset:20992
    v_mfma_f32_32x32x16_bf16 v[80:95], v[192:195], v[100:103], v[80:95]
    ds_read_b64_tr_b16 v[116:117], v13 offset:20480
    ds_read_b64_tr_b16 v[118:119], v13 offset:20992
    s_waitcnt lgkmcnt(5)
    v_mfma_f32_32x32x16_bf16 v[64:79], v[196:199], v[104:107], v[64:79]
    ds_read_b128 v[204:207], v11
    ds_read_b64_tr_b16 v[120:121], v12 offset:22528
    ds_read_b64_tr_b16 v[122:123], v12 offset:23040
    v_mfma_f32_32x32x16_bf16 v[80:95], v[196:199], v[108:111], v[80:95]
    ds_read_b64_tr_b16 v[124:125], v13 offset:22528
    ds_read_b64_tr_b16 v[126:127], v13 offset:23040
    s_waitcnt lgkmcnt(5)
    v_mfma_f32_32x32x16_bf16 v[64:79], v[200:203], v[112:115], v[64:79]
    v_subrev_u32 v8, 131072, v8
    v_subrev_u32 v9, 131072, v9
    v_subrev_u32 v10, 131072, v10
    v_subrev_u32 v11, 131072, v11
    v_subrev_u32 v12, 131072, v12
    v_subrev_u32 v13, 131072, v13
    s_barrier
    ds_read_b128 v[208:211], v8
    ds_read_b64_tr_b16 v[96:97], v12 offset:16384
    ds_read_b64_tr_b16 v[98:99], v12 offset:16896
    v_mfma_f32_32x32x16_bf16 v[80:95], v[200:203], v[116:119], v[80:95]
    ds_read_b64_tr_b16 v[100:101], v13 offset:16384
    ds_read_b64_tr_b16 v[102:103], v13 offset:16896
    s_waitcnt lgkmcnt(5)
    v_mfma_f32_32x32x16_bf16 v[64:79], v[204:207], v[120:123], v[64:79]
    ds_read_b128 v[212:215], v9
    ds_read_b64_tr_b16 v[104:105], v12 offset:18432
    ds_read_b64_tr_b16 v[106:107], v12 offset:18944
    v_mfma_f32_32x32x16_bf16 v[80:95], v[204:207], v[124:127], v[80:95]
    ds_read_b64_tr_b16 v[108:109], v13 offset:18432
    ds_read_b64_tr_b16 v[110:111], v13 offset:18944
    s_waitcnt lgkmcnt(5)
    v_mfma_f32_32x32x16_bf16 v[64:79], v[208:211], v[96:99], v[64:79]
    ds_read_b128 v[216:219], v10
    ds_read_b64_tr_b16 v[112:113], v12 offset:20480
    ds_read_b64_tr_b16 v[114:115], v12 offset:20992
    v_mfma_f32_32x32x16_bf16 v[80:95], v[208:211], v[100:103], v[80:95]
    ds_read_b64_tr_b16 v[116:117], v13 offset:20480
    ds_read_b64_tr_b16 v[118:119], v13 offset:20992
    s_waitcnt lgkmcnt(5)
    v_mfma_f32_32x32x16_bf16 v[64:79], v[212:215], v[104:107], v[64:79]
    ds_read_b128 v[220:223], v11
    ds_read_b64_tr_b16 v[120:121], v12 offset:22528
    ds_read_b64_tr_b16 v[122:123], v12 offset:23040
    v_mfma_f32_32x32x16_bf16 v[80:95], v[212:215], v[108:111], v[80:95]
    ds_read_b64_tr_b16 v[124:125], v13 offset:22528
    ds_read_b64_tr_b16 v[126:127], v13 offset:23040
    s_waitcnt lgkmcnt(5)
    v_mfma_f32_32x32x16_bf16 v[64:79], v[216:219], v[112:115], v[64:79]
    v_add_u32 v8, 32768, v8
    v_add_u32 v9, 32768, v9
    v_add_u32 v10, 32768, v10
    v_add_u32 v11, 32768, v11
    v_add_u32 v12, 32768, v12
    v_add_u32 v13, 32768, v13
    buffer_load_dword v16, off, s[56:59], 0 sc1
    s_barrier
    ds_read_b128 v[224:227], v8
    ds_read_b64_tr_b16 v[96:97], v12 offset:16384
    ds_read_b64_tr_b16 v[98:99], v12 offset:16896
    v_mfma_f32_32x32x16_bf16 v[80:95], v[216:219], v[116:119], v[80:95]
    ds_read_b64_tr_b16 v[100:101], v13 offset:16384
    ds_read_b64_tr_b16 v[102:103], v13 offset:16896
    s_waitcnt lgkmcnt(5)
    v_mfma_f32_32x32x16_bf16 v[64:79], v[220:223], v[120:123], v[64:79]
    ds_read_b128 v[228:231], v9
    ds_read_b64_tr_b16 v[104:105], v12 offset:18432
    ds_read_b64_tr_b16 v[106:107], v12 offset:18944
    v_mfma_f32_32x32x16_bf16 v[80:95], v[220:223], v[124:127], v[80:95]
    ds_read_b64_tr_b16 v[108:109], v13 offset:18432
    ds_read_b64_tr_b16 v[110:111], v13 offset:18944
    s_waitcnt lgkmcnt(5)
    v_mfma_f32_32x32x16_bf16 v[64:79], v[224:227], v[96:99], v[64:79]
    ds_read_b128 v[232:235], v10
    ds_read_b64_tr_b16 v[112:113], v12 offset:20480
    ds_read_b64_tr_b16 v[114:115], v12 offset:20992
    v_mfma_f32_32x32x16_bf16 v[80:95], v[224:227], v[100:103], v[80:95]
    ds_read_b64_tr_b16 v[116:117], v13 offset:20480
    ds_read_b64_tr_b16 v[118:119], v13 offset:20992
    s_waitcnt lgkmcnt(5)
    v_mfma_f32_32x32x16_bf16 v[64:79], v[228:231], v[104:107], v[64:79]
    ds_read_b128 v[236:239], v11
    ds_read_b64_tr_b16 v[120:121], v12 offset:22528
    ds_read_b64_tr_b16 v[122:123], v12 offset:23040
    v_mfma_f32_32x32x16_bf16 v[80:95], v[228:231], v[108:111], v[80:95]
    ds_read_b64_tr_b16 v[124:125], v13 offset:22528
    ds_read_b64_tr_b16 v[126:127], v13 offset:23040
    s_waitcnt lgkmcnt(5)
    v_mfma_f32_32x32x16_bf16 v[64:79], v[232:235], v[112:115], v[64:79]
    v_add_u32 v8, 32768, v8
    v_add_u32 v9, 32768, v9
    v_add_u32 v10, 32768, v10
    v_add_u32 v11, 32768, v11
    v_add_u32 v12, 32768, v12
    v_add_u32 v13, 32768, v13
    ds_read_b128 v[240:243], v8
    ds_read_b64_tr_b16 v[96:97], v12 offset:16384
    ds_read_b64_tr_b16 v[98:99], v12 offset:16896
    v_mfma_f32_32x32x16_bf16 v[80:95], v[232:235], v[116:119], v[80:95]
    ds_read_b64_tr_b16 v[100:101], v13 offset:16384
    ds_read_b64_tr_b16 v[102:103], v13 offset:16896
    s_waitcnt lgkmcnt(5)
    v_mfma_f32_32x32x16_bf16 v[64:79], v[236:239], v[120:123], v[64:79]
    ds_read_b128 v[244:247], v9
    ds_read_b64_tr_b16 v[104:105], v12 offset:18432
    ds_read_b64_tr_b16 v[106:107], v12 offset:18944
    v_mfma_f32_32x32x16_bf16 v[80:95], v[236:239], v[124:127], v[80:95]
    ds_read_b64_tr_b16 v[108:109], v13 offset:18432
    ds_read_b64_tr_b16 v[110:111], v13 offset:18944
    s_waitcnt lgkmcnt(5)
    v_mfma_f32_32x32x16_bf16 v[64:79], v[240:243], v[96:99], v[64:79]
    ds_read_b128 v[248:251], v10
    ds_read_b64_tr_b16 v[112:113], v12 offset:20480
    ds_read_b64_tr_b16 v[114:115], v12 offset:20992
    v_mfma_f32_32x32x16_bf16 v[80:95], v[240:243], v[100:103], v[80:95]
    ds_read_b64_tr_b16 v[116:117], v13 offset:20480
    ds_read_b64_tr_b16 v[118:119], v13 offset:20992
    s_waitcnt lgkmcnt(5)
    v_mfma_f32_32x32x16_bf16 v[64:79], v[244:247], v[104:107], v[64:79]
    ds_read_b128 v[252:255], v11
    ds_read_b64_tr_b16 v[120:121], v12 offset:22528
    ds_read_b64_tr_b16 v[122:123], v12 offset:23040
    v_mfma_f32_32x32x16_bf16 v[80:95], v[244:247], v[108:111], v[80:95]
    ds_read_b64_tr_b16 v[124:125], v13 offset:22528
    ds_read_b64_tr_b16 v[126:127], v13 offset:23040
    s_waitcnt lgkmcnt(5)
    v_mfma_f32_32x32x16_bf16 v[64:79], v[248:251], v[112:115], v[64:79]
    v_mfma_f32_32x32x16_bf16 v[80:95], v[248:251], v[116:119], v[80:95]
    s_waitcnt lgkmcnt(0)
    v_mfma_f32_32x32x16_bf16 v[64:79], v[252:255], v[120:123], v[64:79]
    v_mfma_f32_32x32x16_bf16 v[80:95], v[252:255], v[124:127], v[80:95]
gated_mix__spectral_fnet__sliding_block__prompt_kernel_p1d:
    s_waitcnt vmcnt(0)
    s_mov_b32 s15, 0
gm_n0:
    v_readfirstlane_b32 s63, v16
    s_add_u32 s15, s15, 1
    s_cmp_lg_u32 s63, 0
    s_cbranch_scc1 gm_n1
    s_cmp_gt_u32 s15, 0x40000
    s_cbranch_scc1 gm_n1
    s_sleep 2
    buffer_load_dword v16, off, s[56:59], 0 sc1
    s_waitcnt vmcnt(0)
    s_branch gm_n0
gm_n1:
    s_nop 5
    v_cvt_pk_bf16_f32 v32, v64, v65
    v_cvt_pk_bf16_f32 v33, v66, v67
    v_cvt_pk_bf16_f32 v34, v68, v69
    v_cvt_pk_bf16_f32 v35, v70, v71
    v_cvt_pk_bf16_f32 v36, v72, v73
    v_cvt_pk_bf16_f32 v37, v74, v75
    v_cvt_pk_bf16_f32 v38, v76, v77
    v_cvt_pk_bf16_f32 v39, v78, v79
    buffer_store_dwordx4 v[32:35], v15, s[48:51], s8 offen offset:0 sc1
    buffer_store_dwordx4 v[36:39], v15, s[48:51], s8 offen offset:1024 sc1
    v_cvt_pk_bf16_f32 v40, v80, v81
    v_cvt_pk_bf16_f32 v41, v82, v83
    v_cvt_pk_bf16_f32 v42, v84, v85
    v_cvt_pk_bf16_f32 v43, v86, v87
    v_cvt_pk_bf16_f32 v44, v88, v89
    v_cvt_pk_bf16_f32 v45, v90, v91
    v_cvt_pk_bf16_f32 v46, v92, v93
    v_cvt_pk_bf16_f32 v47, v94, v95
    buffer_store_dwordx4 v[40:43], v15, s[48:51], s60 offen offset:0 sc1
    buffer_store_dwordx4 v[44:47], v15, s[48:51], s60 offen offset:1024 sc1
    s_mov_b64 exec, 1
    ds_add_u32 v28, v29 offset:0
    s_mov_b64 exec, -1
    s_lshr_b32 s9, s3, 1
    s_lshl_b32 s9, s9, 3
    v_bfe_u32 v120, v0, 1, 3
    v_add_u32 v120, s9, v120
    v_cvt_f32_u32 v120, v120
    v_and_b32 v121, 1, v0
    v_lshrrev_b32 v6, 5, v0
    v_sub_u32 v121, v121, v6
    v_cvt_f32_i32 v121, v121
    v_mul_f32 v121, 0x3e800000, v121
    v_bfe_u32 v6, v0, 4, 1
    v_lshlrev_b32 v6, 9, v6
    s_lshl_b32 s9, s64, 2
    v_add_u32 v6, s9, v6
    v_cvt_f32_u32 v6, v6
    v_mul_f32 v122, 0x3a000000, v120
    v_fmac_f32 v121, v6, v122
    v_mul_f32 v120, 0x3d800000, v120
    v_fmamk_f32 v4, v120, 0x00000000, v121
    v_add_f32 v5, v4, v120
    v_cos_f32 v4, v4
    v_cos_f32 v5, v5
    s_nop 0
    v_cvt_pk_bf16_f32 v48, v4, v5
    v_fmamk_f32 v4, v120, 0x40000000, v121
    v_add_f32 v5, v4, v120
    v_cos_f32 v4, v4
    v_cos_f32 v5, v5
    s_nop 0
    v_cvt_pk_bf16_f32 v49, v4, v5
    v_fmamk_f32 v4, v120, 0x41000000, v121
    v_add_f32 v5, v4, v120
    v_cos_f32 v4, v4
    v_cos_f32 v5, v5
    s_nop 0
    v_cvt_pk_bf16_f32 v50, v4, v5
    v_fmamk_f32 v4, v120, 0x41200000, v121
    v_add_f32 v5, v4, v120
    v_cos_f32 v4, v4
    v_cos_f32 v5, v5
    s_nop 0
    v_cvt_pk_bf16_f32 v51, v4, v5
    v_add_f32 v121, v121, v122
    v_fmamk_f32 v4, v120, 0x00000000, v121
    v_add_f32 v5, v4, v120
    v_cos_f32 v4, v4
    v_cos_f32 v5, v5
    s_nop 0
    v_cvt_pk_bf16_f32 v52, v4, v5
    v_fmamk_f32 v4, v120, 0x40000000, v121
    v_add_f32 v5, v4, v120
    v_cos_f32 v4, v4
    v_cos_f32 v5, v5
    s_nop 0
    v_cvt_pk_bf16_f32 v53, v4, v5
    v_fmamk_f32 v4, v120, 0x41000000, v121
    v_add_f32 v5, v4, v120
    v_cos_f32 v4, v4
    v_cos_f32 v5, v5
    s_nop 0
    v_cvt_pk_bf16_f32 v54, v4, v5
    v_fmamk_f32 v4, v120, 0x41200000, v121
    v_add_f32 v5, v4, v120
    v_cos_f32 v4, v4
    v_cos_f32 v5, v5
    s_nop 0
    v_cvt_pk_bf16_f32 v55, v4, v5
    v_add_f32 v121, v121, v122
    v_fmamk_f32 v4, v120, 0x00000000, v121
    v_add_f32 v5, v4, v120
    v_cos_f32 v4, v4
    v_cos_f32 v5, v5
    s_nop 0
    v_cvt_pk_bf16_f32 v56, v4, v5
    v_fmamk_f32 v4, v120, 0x40000000, v121
    v_add_f32 v5, v4, v120
    v_cos_f32 v4, v4
    v_cos_f32 v5, v5
    s_nop 0
    v_cvt_pk_bf16_f32 v57, v4, v5
    v_fmamk_f32 v4, v120, 0x41000000, v121
    v_add_f32 v5, v4, v120
    v_cos_f32 v4, v4
    v_cos_f32 v5, v5
    s_nop 0
    v_cvt_pk_bf16_f32 v58, v4, v5
    v_fmamk_f32 v4, v120, 0x41200000, v121
    v_add_f32 v5, v4, v120
    v_cos_f32 v4, v4
    v_cos_f32 v5, v5
    s_nop 0
    v_cvt_pk_bf16_f32 v59, v4, v5
    v_add_f32 v121, v121, v122
    v_fmamk_f32 v4, v120, 0x00000000, v121
    v_add_f32 v5, v4, v120
    v_cos_f32 v4, v4
    v_cos_f32 v5, v5
    s_nop 0
    v_cvt_pk_bf16_f32 v60, v4, v5
    v_fmamk_f32 v4, v120, 0x40000000, v121
    v_add_f32 v5, v4, v120
    v_cos_f32 v4, v4
    v_cos_f32 v5, v5
    s_nop 0
    v_cvt_pk_bf16_f32 v61, v4, v5
    v_fmamk_f32 v4, v120, 0x41000000, v121
    v_add_f32 v5, v4, v120
    v_cos_f32 v4, v4
    v_cos_f32 v5, v5
    s_nop 0
    v_cvt_pk_bf16_f32 v62, v4, v5
    v_fmamk_f32 v4, v120, 0x41200000, v121
    v_add_f32 v5, v4, v120
    v_cos_f32 v4, v4
    v_cos_f32 v5, v5
    s_nop 0
    v_cvt_pk_bf16_f32 v63, v4, v5
lw9:
    ds_read_b32 v30, v28 offset:0
    s_waitcnt lgkmcnt(0)
    v_readfirstlane_b32 s78, v30
    s_cmp_lt_u32 s78, 8
    s_cbranch_scc1 lw9
    ds_read_b64_tr_b16 v[96:97], v14 offset:0
    ds_read_b64_tr_b16 v[98:99], v14 offset:256
    ds_read_b64_tr_b16 v[100:101], v14 offset:1024
    ds_read_b64_tr_b16 v[102:103], v14 offset:1280
    ds_read_b64_tr_b16 v[104:105], v14 offset:2048
    ds_read_b64_tr_b16 v[106:107], v14 offset:2304
    ds_read_b64_tr_b16 v[108:109], v14 offset:3072
    ds_read_b64_tr_b16 v[110:111], v14 offset:3328
    ds_read_b64_tr_b16 v[112:113], v14 offset:4096
    ds_read_b64_tr_b16 v[114:115], v14 offset:4352
    ds_read_b64_tr_b16 v[116:117], v14 offset:5120
    ds_read_b64_tr_b16 v[118:119], v14 offset:5376
    s_waitcnt lgkmcnt(10)
    v_mfma_f32_32x32x16_bf16 v[64:79], v[96:99], v[128:131], 0
    ds_read_b64_tr_b16 v[120:121], v14 offset:6144
    ds_read_b64_tr_b16 v[122:123], v14 offset:6400
    s_waitcnt lgkmcnt(10)
    v_mfma_f32_32x32x16_bf16 v[64:79], v[100:103], v[132:135], v[64:79]
    ds_read_b64_tr_b16 v[124:125], v14 offset:7168
    ds_read_b64_tr_b16 v[126:127], v14 offset:7424
    s_waitcnt lgkmcnt(10)
    v_mfma_f32_32x32x16_bf16 v[64:79], v[104:107], v[136:139], v[64:79]
    ds_read_b64_tr_b16 v[96:97], v14 offset:8192
    ds_read_b64_tr_b16 v[98:99], v14 offset:8448
    s_waitcnt lgkmcnt(10)
    v_mfma_f32_32x32x16_bf16 v[64:79], v[108:111], v[140:143], v[64:79]
    ds_read_b64_tr_b16 v[100:101], v14 offset:9216
    ds_read_b64_tr_b16 v[102:103], v14 offset:9472
    s_waitcnt lgkmcnt(10)
    v_mfma_f32_32x32x16_bf16 v[64:79], v[112:115], v[144:147], v[64:79]
    ds_read_b64_tr_b16 v[104:105], v14 offset:10240
    ds_read_b64_tr_b16 v[106:107], v14 offset:10496
    s_waitcnt lgkmcnt(10)
    v_mfma_f32_32x32x16_bf16 v[64:79], v[116:119], v[148:151], v[64:79]
    ds_read_b64_tr_b16 v[108:109], v14 offset:11264
    ds_read_b64_tr_b16 v[110:111], v14 offset:11520
    s_waitcnt lgkmcnt(10)
    v_mfma_f32_32x32x16_bf16 v[64:79], v[120:123], v[152:155], v[64:79]
    ds_read_b64_tr_b16 v[112:113], v14 offset:12288
    ds_read_b64_tr_b16 v[114:115], v14 offset:12544
    s_waitcnt lgkmcnt(10)
    v_mfma_f32_32x32x16_bf16 v[64:79], v[124:127], v[156:159], v[64:79]
    ds_read_b64_tr_b16 v[116:117], v14 offset:13312
    ds_read_b64_tr_b16 v[118:119], v14 offset:13568
    s_waitcnt lgkmcnt(10)
    v_mfma_f32_32x32x16_bf16 v[64:79], v[96:99], v[160:163], v[64:79]
    ds_read_b64_tr_b16 v[120:121], v14 offset:14336
    ds_read_b64_tr_b16 v[122:123], v14 offset:14592
    s_waitcnt vmcnt(0)
    s_mov_b64 exec, 1
    buffer_store_dword v16, off, s[48:51], s77 sc1
    s_mov_b64 exec, -1
    s_waitcnt lgkmcnt(10)
    v_mfma_f32_32x32x16_bf16 v[64:79], v[100:103], v[164:167], v[64:79]
    ds_read_b64_tr_b16 v[124:125], v14 offset:15360
    ds_read_b64_tr_b16 v[126:127], v14 offset:15616
    s_waitcnt lgkmcnt(10)
    v_mfma_f32_32x32x16_bf16 v[64:79], v[104:107], v[168:171], v[64:79]
    ds_read_b64_tr_b16 v[96:97], v14 offset:16384
    ds_read_b64_tr_b16 v[98:99], v14 offset:16640
    s_waitcnt lgkmcnt(10)
    v_mfma_f32_32x32x16_bf16 v[64:79], v[108:111], v[172:175], v[64:79]
    ds_read_b64_tr_b16 v[100:101], v14 offset:17408
    ds_read_b64_tr_b16 v[102:103], v14 offset:17664
    s_waitcnt lgkmcnt(10)
    v_mfma_f32_32x32x16_bf16 v[64:79], v[112:115], v[176:179], v[64:79]
    ds_read_b64_tr_b16 v[104:105], v14 offset:18432
    ds_read_b64_tr_b16 v[106:107], v14 offset:18688
    s_waitcnt lgkmcnt(10)
    v_mfma_f32_32x32x16_bf16 v[64:79], v[116:119], v[180:183], v[64:79]
    ds_read_b64_tr_b16 v[108:109], v14 offset:19456
    ds_read_b64_tr_b16 v[110:111], v14 offset:19712
    s_waitcnt lgkmcnt(10)
    v_mfma_f32_32x32x16_bf16 v[64:79], v[120:123], v[184:187], v[64:79]
    ds_read_b64_tr_b16 v[112:113], v14 offset:20480
    ds_read_b64_tr_b16 v[114:115], v14 offset:20736
    s_waitcnt lgkmcnt(10)
    v_mfma_f32_32x32x16_bf16 v[64:79], v[124:127], v[188:191], v[64:79]
    ds_read_b64_tr_b16 v[116:117], v14 offset:21504
    ds_read_b64_tr_b16 v[118:119], v14 offset:21760
    s_waitcnt lgkmcnt(10)
    v_mfma_f32_32x32x16_bf16 v[64:79], v[96:99], v[192:195], v[64:79]
    ds_read_b64_tr_b16 v[120:121], v14 offset:22528
    ds_read_b64_tr_b16 v[122:123], v14 offset:22784
    s_waitcnt lgkmcnt(10)
    v_mfma_f32_32x32x16_bf16 v[64:79], v[100:103], v[196:199], v[64:79]
    ds_read_b64_tr_b16 v[124:125], v14 offset:23552
    ds_read_b64_tr_b16 v[126:127], v14 offset:23808
    s_waitcnt lgkmcnt(10)
    v_mfma_f32_32x32x16_bf16 v[64:79], v[104:107], v[200:203], v[64:79]
    ds_read_b64_tr_b16 v[96:97], v14 offset:24576
    ds_read_b64_tr_b16 v[98:99], v14 offset:24832
    s_waitcnt lgkmcnt(10)
    v_mfma_f32_32x32x16_bf16 v[64:79], v[108:111], v[204:207], v[64:79]
    ds_read_b64_tr_b16 v[100:101], v14 offset:25600
    ds_read_b64_tr_b16 v[102:103], v14 offset:25856
    s_waitcnt lgkmcnt(10)
    v_mfma_f32_32x32x16_bf16 v[64:79], v[112:115], v[208:211], v[64:79]
    ds_read_b64_tr_b16 v[104:105], v14 offset:26624
    ds_read_b64_tr_b16 v[106:107], v14 offset:26880
    s_waitcnt lgkmcnt(10)
    v_mfma_f32_32x32x16_bf16 v[64:79], v[116:119], v[212:215], v[64:79]
    ds_read_b64_tr_b16 v[108:109], v14 offset:27648
    ds_read_b64_tr_b16 v[110:111], v14 offset:27904
    s_waitcnt lgkmcnt(10)
    v_mfma_f32_32x32x16_bf16 v[64:79], v[120:123], v[216:219], v[64:79]
    ds_read_b64_tr_b16 v[112:113], v14 offset:28672
    ds_read_b64_tr_b16 v[114:115], v14 offset:28928
    s_waitcnt lgkmcnt(10)
    v_mfma_f32_32x32x16_bf16 v[64:79], v[124:127], v[220:223], v[64:79]
    ds_read_b64_tr_b16 v[116:117], v14 offset:29696
    ds_read_b64_tr_b16 v[118:119], v14 offset:29952
    s_waitcnt lgkmcnt(10)
    v_mfma_f32_32x32x16_bf16 v[64:79], v[96:99], v[224:227], v[64:79]
    ds_read_b64_tr_b16 v[120:121], v14 offset:30720
    ds_read_b64_tr_b16 v[122:123], v14 offset:30976
    s_waitcnt lgkmcnt(10)
    v_mfma_f32_32x32x16_bf16 v[64:79], v[100:103], v[228:231], v[64:79]
    ds_read_b64_tr_b16 v[124:125], v14 offset:31744
    ds_read_b64_tr_b16 v[126:127], v14 offset:32000
    s_waitcnt lgkmcnt(10)
    v_mfma_f32_32x32x16_bf16 v[64:79], v[104:107], v[232:235], v[64:79]
    s_waitcnt lgkmcnt(8)
    v_mfma_f32_32x32x16_bf16 v[64:79], v[108:111], v[236:239], v[64:79]
    s_waitcnt lgkmcnt(6)
    v_mfma_f32_32x32x16_bf16 v[64:79], v[112:115], v[240:243], v[64:79]
    s_waitcnt lgkmcnt(4)
    v_mfma_f32_32x32x16_bf16 v[64:79], v[116:119], v[244:247], v[64:79]
    s_waitcnt lgkmcnt(2)
    v_mfma_f32_32x32x16_bf16 v[64:79], v[120:123], v[248:251], v[64:79]
    s_waitcnt lgkmcnt(0)
    v_mfma_f32_32x32x16_bf16 v[64:79], v[124:127], v[252:255], v[64:79]
    s_mov_b32 s76, 11010048
    s_mov_b64 exec, 63
    v_mov_b32 v19, 0
    buffer_atomic_add v19, v18, s[48:51], s76 offen sc0 sc1
    s_mov_b64 exec, -1
    s_lshl_b32 s9, s3, 10
    s_add_u32 s9, s9, 81920
    v_add_u32 v4, s9, v15
    s_nop 8
    v_mul_f32 v64, 0x3eb8aa3b, v64
    v_mul_f32 v65, 0x3eb8aa3b, v65
    v_mul_f32 v66, 0x3eb8aa3b, v66
    v_mul_f32 v67, 0x3eb8aa3b, v67
    v_mul_f32 v68, 0x3eb8aa3b, v68
    v_mul_f32 v69, 0x3eb8aa3b, v69
    v_mul_f32 v70, 0x3eb8aa3b, v70
    v_mul_f32 v71, 0x3eb8aa3b, v71
    v_mul_f32 v72, 0x3eb8aa3b, v72
    v_mul_f32 v73, 0x3eb8aa3b, v73
    v_mul_f32 v74, 0x3eb8aa3b, v74
    v_mul_f32 v75, 0x3eb8aa3b, v75
    v_mul_f32 v76, 0x3eb8aa3b, v76
    v_mul_f32 v77, 0x3eb8aa3b, v77
    v_mul_f32 v78, 0x3eb8aa3b, v78
    v_mul_f32 v79, 0x3eb8aa3b, v79
    v_cvt_pk_bf16_f32 v20, v64, v65
    v_cvt_pk_bf16_f32 v21, v66, v67
    v_cvt_pk_bf16_f32 v22, v68, v69
    v_cvt_pk_bf16_f32 v23, v70, v71
    v_cvt_pk_bf16_f32 v24, v72, v73
    v_cvt_pk_bf16_f32 v25, v74, v75
    v_cvt_pk_bf16_f32 v26, v76, v77
    v_cvt_pk_bf16_f32 v27, v78, v79
    ds_write_b128 v4, v[24:27]
    s_mov_b32 s15, 0
    s_mov_b64 exec, 63
gm_poll:
    s_add_u32 s15, s15, 1
    s_waitcnt vmcnt(0)
    v_cmp_ne_u32 vcc, s63, v19
    s_cmp_gt_u32 s15, 0x40000
    s_cbranch_scc1 gm_polled
    s_cbranch_vccz gm_polled
    s_sleep 0
    v_mov_b32 v19, 0
    buffer_atomic_add v19, v18, s[48:51], s76 offen sc0 sc1
    s_branch gm_poll
gm_polled:
    s_mov_b64 exec, -1
    s_mul_i32 s12, s3, 12288
    s_lshl_b32 s13, s7, 6
    s_add_u32 s11, s66, 0
    s_cmp_lt_i32 s11, 0
    s_cselect_b32 s11, s67, s11
    s_add_u32 s11, s11, s13
    s_lshl_b32 s11, s11, 12
    s_add_u32 m0, s12, 32768
    s_nop 0
    buffer_load_dwordx4 v15, s[48:51], s11 offen offset:0 sc1 lds
    buffer_load_dwordx4 v15, s[48:51], s11 offen offset:1024 sc1 lds
    buffer_load_dwordx4 v15, s[48:51], s11 offen offset:2048 sc1 lds
    buffer_load_dwordx4 v15, s[48:51], s11 offen offset:3072 sc1 lds
    s_add_u32 s11, s66, 1
    s_cmp_lt_i32 s11, 0
    s_cselect_b32 s11, s67, s11
    s_add_u32 s11, s11, s13
    s_lshl_b32 s11, s11, 12
    s_add_u32 m0, s12, 36864
    s_nop 0
    buffer_load_dwordx4 v15, s[48:51], s11 offen offset:0 sc1 lds
    buffer_load_dwordx4 v15, s[48:51], s11 offen offset:1024 sc1 lds
    buffer_load_dwordx4 v15, s[48:51], s11 offen offset:2048 sc1 lds
    buffer_load_dwordx4 v15, s[48:51], s11 offen offset:3072 sc1 lds
    s_add_u32 s11, s66, 2
    s_cmp_lt_i32 s11, 0
    s_cselect_b32 s11, s67, s11
    s_add_u32 s11, s11, s13
    s_lshl_b32 s11, s11, 12
    s_add_u32 m0, s12, 40960
    s_nop 0
    buffer_load_dwordx4 v15, s[48:51], s11 offen offset:0 sc1 lds
    buffer_load_dwordx4 v15, s[48:51], s11 offen offset:1024 sc1 lds
    buffer_load_dwordx4 v15, s[48:51], s11 offen offset:2048 sc1 lds
    buffer_load_dwordx4 v15, s[48:51], s11 offen offset:3072 sc1 lds
    v_and_b32 v2, 31, v0
    v_lshrrev_b32 v3, 5, v0
    v_lshlrev_b32 v4, v2, -2
    v_lshlrev_b32 v5, 2, v3
    v_lshrrev_b32 v4, v5, v4
    s_mov_b32 s13, 0xffff
    v_bfe_i32 v192, v4, 0, 1
    v_bfe_i32 v193, v4, 1, 1
    v_bfe_i32 v194, v4, 2, 1
    v_bfe_i32 v195, v4, 3, 1
    v_bfe_i32 v196, v4, 8, 1
    v_bfe_i32 v197, v4, 9, 1
    v_bfe_i32 v198, v4, 10, 1
    v_bfe_i32 v199, v4, 11, 1
    v_bfe_i32 v200, v4, 16, 1
    v_bfe_i32 v201, v4, 17, 1
    v_bfe_i32 v202, v4, 18, 1
    v_bfe_i32 v203, v4, 19, 1
    v_bfe_i32 v204, v4, 24, 1
    v_bfe_i32 v205, v4, 25, 1
    v_bfe_i32 v206, v4, 26, 1
    v_bfe_i32 v207, v4, 27, 1
    v_bfi_b32 v208, s13, v192, v193
    v_bfi_b32 v209, s13, v194, v195
    v_bfi_b32 v210, s13, v196, v197
    v_bfi_b32 v211, s13, v198, v199
    v_bfi_b32 v212, s13, v200, v201
    v_bfi_b32 v213, s13, v202, v203
    v_bfi_b32 v214, s13, v204, v205
    v_bfi_b32 v215, s13, v206, v207
    v_mov_b32 v216, 0x3f803f80
    v_mov_b32 v217, v216
    v_mov_b64 v[218:219], v[216:217]
    v_mov_b64 v[220:221], v[216:217]
    v_mov_b64 v[222:223], v[216:217]
    v_mov_b64 v[224:225], v[216:217]
    v_mov_b64 v[226:227], v[216:217]
    v_mov_b64 v[228:229], v[216:217]
    v_mov_b64 v[230:231], v[216:217]
    v_mov_b64 v[232:233], v[216:217]
    v_mov_b64 v[234:235], v[216:217]
    v_mov_b64 v[236:237], v[216:217]
    v_mov_b64 v[238:239], v[216:217]
    v_mov_b64 v[240:241], v[216:217]
    v_mov_b64 v[242:243], v[216:217]
    v_mov_b64 v[244:245], v[216:217]
    v_mov_b64 v[246:247], v[216:217]
    s_and_b32 s9, s3, 3
    s_lshr_b32 s10, s3, 2
    s_lshl_b32 s11, s9, 12
    s_add_u32 s11, s11, 32768
    s_lshl_b32 s12, s10, 10
    s_add_u32 s12, s12, s11
    v_lshlrev_b32 v4, 4, v0
    v_add_u32 v8, s12, v4
    s_lshl_b32 s12, s10, 8
    s_add_u32 s12, s12, s11
    v_add_u32 v9, s12, v4
    v_and_b32 v5, 15, v0
    v_mul_u32_u24 v5, 528, v5
    s_and_b32 s12, s4, 1
    v_xor_b32 v6, s12, v3
    v_lshl_add_u32 v5, v6, 7, v5
    v_bfe_u32 v6, v0, 4, 1
    v_lshl_add_u32 v5, v6, 4, v5
    s_lshl_b32 s12, s10, 8
    s_lshl_b32 s11, s9, 5
    s_add_u32 s12, s12, s11
    s_add_u32 s12, s12, 16384
    v_add_u32 v10, s12, v5
    s_mul_i32 s12, s3, 1056
    s_add_u32 s12, s12, 16384
    v_mul_u32_u24 v5, 528, v3
    v_lshl_add_u32 v5, v2, 4, v5
    v_add_u32 v11, s12, v5
    v_mul_u32_u24 v5, 132096, v3
    v_lshl_add_u32 v12, v2, 4, v5
    s_lshl_b32 s61, s4, 2
    s_add_u32 s61, s61, s9
    s_add_u32 s61, s61, 1
    s_min_u32 s61, s61, 9
    s_mul_i32 s62, s3, 264192
    s_lshr_b32 s11, s4, 3
    s_lshl_b32 s11, s11, 16
    s_add_u32 s62, s62, s11
    s_lshl_b32 s11, s7, 12
    s_add_u32 s62, s62, s11
    s_and_b32 s11, s4, 7
    s_lshl_b32 s11, s11, 9
    s_add_u32 s62, s62, s11
    s_add_u32 s62, s62, 7340032
    s_and_b32 s72, s2, 7
    s_lshl_b32 s72, s72, 1
    s_bfe_u32 s11, s2, 0x10003
    s_add_u32 s72, s72, s11
    s_bfe_u32 s73, s2, 0x10004
    s_lshr_b32 s74, s2, 5
    s_mov_b32 s75, 0
    v_lshlrev_b32 v14, 4, v0
    v_lshrrev_b32 v4, 3, v0
    v_lshlrev_b32 v4, 10, v4
    v_bfe_u32 v5, v0, 2, 1
    v_bfe_u32 v6, v0, 4, 1
    v_xor_b32 v5, v5, v6
    v_lshl_add_u32 v4, v5, 6, v4
    v_and_b32 v5, 3, v0
    v_lshl_add_u32 v4, v5, 4, v4
    s_lshl_b32 s11, s3, 16
    s_lshl_b32 s12, s74, 7
    s_add_u32 s11, s11, s12
    v_add_u32 v13, s11, v4
    s_mov_b32 s68, s30
    s_mov_b32 s69, s31
    s_mov_b32 s70, 524288
    s_mov_b32 s71, 0x00020000
    s_lshl_b32 s9, s74, 1
    s_lshr_b32 s10, s3, 1
    s_add_u32 s9, s9, s10
    s_sub_u32 s10, 15, s9
    s_min_u32 s10, s10, s9
    v_and_b32 v5, 1, v0
    v_add_u32 v5, s10, v5
    v_and_b32 v5, 7, v5
    v_lshrrev_b32 v6, 1, v0
    v_lshl_add_u32 v5, v6, 3, v5
    v_lshlrev_b32 v18, 8, v5
    s_and_b32 s79, s3, 1
    s_lshl_b32 s79, s79, 15
    s_add_u32 s79, s79, 12058624
    v_mov_b64 v[112:113], 0
    v_mov_b64 v[114:115], 0
    v_mov_b64 v[116:117], 0
    v_mov_b64 v[118:119], 0
    v_mov_b64 v[120:121], 0
    v_mov_b64 v[122:123], 0
    v_mov_b64 v[124:125], 0
    v_mov_b64 v[126:127], 0
    s_lshl_b32 s77, s64, 3
    s_add_u32 s77, s77, s65
    s_lshl_b32 s77, s77, 8
    s_lshl_b32 s9, s3, 2
    s_add_u32 s77, s77, s9
    s_add_u32 s77, s77, 12058624
    v_lshrrev_b32 v4, 5, v0
    v_lshlrev_b32 v3, 12, v4
    v_bfe_u32 v5, v0, 4, 1
    v_lshl_add_u32 v3, v5, 9, v3
    v_and_b32 v6, 15, v0
    v_lshl_add_u32 v3, v6, 4, v3
    s_lshr_b32 s10, s3, 1
    s_and_b32 s9, s3, 1
    s_lshl_b32 s9, s9, 8
    s_add_u32 s11, s9, 86016
    v_add_u32 v3, s11, v3
    v_lshrrev_b32 v4, 4, v0
    v_mul_u32_u24 v4, 270336, v4
    v_lshl_add_u32 v5, v6, 4, v4
    s_lshl_b32 s11, s65, 9
    s_add_u32 s9, s9, s11
    v_add_u32 v5, s9, v5
    s_mul_i32 s10, s10, 1081344
    s_mul_i32 s11, s64, 4224
    s_add_u32 s10, s10, s11
    s_add_u32 s10, s10, 4194304
    s_add_u32 s11, s10, 135168
    v_mov_b64 v[96:97], 0
    v_mov_b64 v[98:99], 0
    v_mov_b64 v[100:101], 0
    v_mov_b64 v[102:103], 0
    v_mov_b64 v[104:105], 0
    v_mov_b64 v[106:107], 0
    v_mov_b64 v[108:109], 0
    v_mov_b64 v[110:111], 0
lw10:
    ds_read_b32 v30, v28 offset:8
    s_waitcnt lgkmcnt(0)
    v_readfirstlane_b32 s78, v30
    s_cmp_lt_u32 s78, 4
    s_cbranch_scc1 lw10
    s_cmp_eq_u32 s9, 0
    s_cselect_b32 exec_hi, 0xfffefffe, -1
    ds_read_b128 v[96:99], v3 offset:0
    ds_read_b128 v[100:103], v3 offset:1024
    ds_read_b128 v[104:107], v3 offset:2048
    ds_read_b128 v[108:111], v3 offset:3072
    s_waitcnt lgkmcnt(0)
    s_mov_b64 exec, -1
    v_mfma_f32_16x16x32_bf16 v[64:67], v[48:51], v[96:99], 0
    v_mfma_f32_16x16x32_bf16 v[68:71], v[52:55], v[100:103], 0
    v_mfma_f32_16x16x32_bf16 v[72:75], v[56:59], v[104:107], 0
    v_mfma_f32_16x16x32_bf16 v[76:79], v[60:63], v[108:111], 0
    s_nop 4
    v_cvt_pk_bf16_f32 v32, v64, v65
    v_cvt_pk_bf16_f32 v33, v68, v69
    v_cvt_pk_bf16_f32 v34, v72, v73
    v_cvt_pk_bf16_f32 v35, v76, v77
    v_cvt_pk_bf16_f32 v36, v66, v67
    v_cvt_pk_bf16_f32 v37, v70, v71
    v_cvt_pk_bf16_f32 v38, v74, v75
    v_cvt_pk_bf16_f32 v39, v78, v79
    buffer_store_dwordx4 v[32:35], v5, s[48:51], s10 offen sc1
    buffer_store_dwordx4 v[36:39], v5, s[48:51], s11 offen sc1
    s_waitcnt vmcnt(2)
    s_mov_b64 exec, 1
    ds_add_u32 v28, v29 offset:12
    s_mov_b64 exec, -1
    s_cmp_lg_u32 s9, 0
    s_cbranch_scc1 gated_mix__spectral_fnet__sliding_block__prompt_kernel_nsp
    s_mov_b32 exec_hi, 0
    ds_read_b128 v[96:99], v3 offset:4096
    ds_read_b128 v[100:103], v3 offset:5120
    ds_read_b128 v[104:107], v3 offset:6144
    ds_read_b128 v[108:111], v3 offset:7168
    s_mov_b64 exec, -1
    v_add_u32 v6, 4096, v4
    s_waitcnt lgkmcnt(0)
    v_mfma_f32_16x16x32_bf16 v[64:67], v[48:51], v[96:99], 0
    v_mfma_f32_16x16x32_bf16 v[68:71], v[52:55], v[100:103], 0
    v_mfma_f32_16x16x32_bf16 v[72:75], v[56:59], v[104:107], 0
    v_mfma_f32_16x16x32_bf16 v[76:79], v[60:63], v[108:111], 0
    s_nop 4
    v_cvt_pk_bf16_f32 v32, v64, v65
    v_cvt_pk_bf16_f32 v33, v68, v69
    v_cvt_pk_bf16_f32 v34, v72, v73
    v_cvt_pk_bf16_f32 v35, v76, v77
    v_cvt_pk_bf16_f32 v36, v66, v67
    v_cvt_pk_bf16_f32 v37, v70, v71
    v_cvt_pk_bf16_f32 v38, v74, v75
    v_cvt_pk_bf16_f32 v39, v78, v79
    s_mov_b32 exec_lo, 0x00010001
    s_mov_b32 exec_hi, 0x00010001
    buffer_store_dwordx4 v[32:35], v6, s[48:51], s10 offen sc1
    buffer_store_dwordx4 v[36:39], v6, s[48:51], s11 offen sc1
    s_mov_b64 exec, -1
gated_mix__spectral_fnet__sliding_block__prompt_kernel_nsp:
lw11:
    ds_read_b32 v30, v28 offset:12
    s_waitcnt lgkmcnt(0)
    v_readfirstlane_b32 s78, v30
    s_cmp_lt_u32 s78, 4
    s_cbranch_scc1 lw11
att_body2:
    s_mov_b32 s12, 0xffff
    s_mov_b32 s13, 0xffff
    s_mov_b32 s15, 0
    s_lshl_b32 s8, s3, 13
    s_add_u32 s8, s8, 98304
att_retry:
    ds_read_b128 v[144:147], v8 offset:32768
    ds_read_b128 v[148:151], v8 offset:0
    ds_read_b128 v[152:155], v8 offset:28672
    ds_read_b128 v[156:159], v8 offset:24576
    s_mov_b64 exec, s[12:13]
    ds_read_b128 v[216:219], v9 offset:34816
    ds_read_b128 v[220:223], v9 offset:35840
    ds_read_b128 v[224:227], v9 offset:2048
    ds_read_b128 v[228:231], v9 offset:3072
    ds_read_b128 v[232:235], v9 offset:30720
    ds_read_b128 v[236:239], v9 offset:31744
    s_mov_b64 exec, -1
    s_setprio 3
    s_waitcnt lgkmcnt(7)
    s_nop 0
    v_mfma_f32_32x32x16_bf16 v[80:95], v[144:147], v[20:23], v[112:127]
    v_mfma_f32_32x32x16_bf16 v[128:143], v[148:151], v[20:23], v[112:127]
    v_mfma_f32_32x32x16_bf16 v[64:79], v[152:155], v[20:23], v[112:127]
    s_add_u32 m0, s75, s8
    s_lshl_b32 s9, s75, 3
    buffer_load_dwordx4 v13, s[68:71], s9 offen lds
    s_add_u32 s75, s75, 1024
    s_cmp_lg_u32 s61, 9
    s_nop 4
    s_cbranch_scc1 att_no0a
    v_bfi_b32 v80, v192, v128, v80
    v_bfi_b32 v81, v193, v129, v81
    v_bfi_b32 v82, v194, v130, v82
    v_bfi_b32 v83, v195, v131, v83
    v_bfi_b32 v84, v196, v132, v84
    v_bfi_b32 v85, v197, v133, v85
    v_bfi_b32 v86, v198, v134, v86
    v_bfi_b32 v87, v199, v135, v87
    v_bfi_b32 v88, v200, v136, v88
    v_bfi_b32 v89, v201, v137, v89
    v_bfi_b32 v90, v202, v138, v90
    v_bfi_b32 v91, v203, v139, v91
    v_bfi_b32 v92, v204, v140, v92
    v_bfi_b32 v93, v205, v141, v93
    v_bfi_b32 v94, v206, v142, v94
    v_bfi_b32 v95, v207, v143, v95
att_no0a:
    v_exp_f32 v80, v80
    v_exp_f32 v81, v81
    v_exp_f32 v82, v82
    v_exp_f32 v83, v83
    v_exp_f32 v84, v84
    v_exp_f32 v85, v85
    v_exp_f32 v86, v86
    v_exp_f32 v87, v87
    v_exp_f32 v88, v88
    v_exp_f32 v89, v89
    v_exp_f32 v90, v90
    v_exp_f32 v91, v91
    v_exp_f32 v92, v92
    v_exp_f32 v93, v93
    v_exp_f32 v94, v94
    v_exp_f32 v95, v95
    v_cvt_pk_bf16_f32 v32, v80, v81
    v_cvt_pk_bf16_f32 v33, v82, v83
    v_cvt_pk_bf16_f32 v34, v84, v85
    v_cvt_pk_bf16_f32 v35, v86, v87
    v_cvt_pk_bf16_f32 v36, v88, v89
    v_cvt_pk_bf16_f32 v37, v90, v91
    v_cvt_pk_bf16_f32 v38, v92, v93
    v_cvt_pk_bf16_f32 v39, v94, v95
    v_and_b32 v40, v208, v32
    v_and_b32 v41, v209, v33
    v_and_b32 v42, v210, v34
    v_and_b32 v43, v211, v35
    v_and_b32 v44, v212, v36
    v_and_b32 v45, v213, v37
    v_and_b32 v46, v214, v38
    v_and_b32 v47, v215, v39
    v_xor_b32 v32, v40, v32
    v_xor_b32 v33, v41, v33
    v_xor_b32 v34, v42, v34
    v_xor_b32 v35, v43, v35
    v_xor_b32 v36, v44, v36
    v_xor_b32 v37, v45, v37
    v_xor_b32 v38, v46, v38
    v_xor_b32 v39, v47, v39
    s_waitcnt lgkmcnt(0)
    s_cmp_lg_u32 s61, 9
    v_mfma_f32_32x32x16_bf16 v[128:143], v[216:219], v[32:35], 0
    v_mfma_f32_32x32x16_bf16 v[128:143], v[220:223], v[36:39], v[128:143]
    s_cbranch_scc1 att_no0b
    v_mfma_f32_32x32x16_bf16 v[128:143], v[224:227], v[40:43], v[128:143]
    v_mfma_f32_32x32x16_bf16 v[128:143], v[228:231], v[44:47], v[128:143]
att_no0b:
    s_cmp_ge_u32 s3, 4
    s_cbranch_scc1 att_nof3
    v_mov_b32 v4, s63
    s_waitcnt vmcnt(1)
    s_mov_b64 exec, 1
    buffer_store_dword v4, off, s[48:51], s77 sc1
    s_mov_b64 exec, -1
att_nof3:
    s_cmp_eq_u32 s61, 1
    s_cbranch_scc1 att_done
    v_mfma_f32_32x32x16_bf16 v[80:95], v[156:159], v[20:23], v[112:127]
    ds_read_b128 v[144:147], v8 offset:20480
    s_mov_b64 exec, s[12:13]
    ds_read_b128 v[240:243], v9 offset:26624
    ds_read_b128 v[244:247], v9 offset:27648
    s_mov_b64 exec, -1
    s_add_u32 m0, s75, s8
    s_lshl_b32 s9, s75, 3
    buffer_load_dwordx4 v13, s[68:71], s9 offen lds
    s_add_u32 s75, s75, 1024
    v_exp_f32 v64, v64
    v_exp_f32 v65, v65
    v_exp_f32 v66, v66
    v_exp_f32 v67, v67
    v_exp_f32 v68, v68
    v_exp_f32 v69, v69
    v_exp_f32 v70, v70
    v_exp_f32 v71, v71
    v_cvt_pk_bf16_f32 v32, v64, v65
    v_cvt_pk_bf16_f32 v33, v66, v67
    v_cvt_pk_bf16_f32 v34, v68, v69
    v_cvt_pk_bf16_f32 v35, v70, v71
    v_exp_f32 v72, v72
    v_exp_f32 v73, v73
    v_mfma_f32_32x32x16_bf16 v[128:143], v[232:235], v[32:35], v[128:143]
    s_add_u32 m0, s75, s8
    s_lshl_b32 s9, s75, 3
    buffer_load_dwordx4 v13, s[68:71], s9 offen lds
    s_add_u32 s75, s75, 1024
    v_exp_f32 v74, v74
    v_exp_f32 v75, v75
    v_exp_f32 v76, v76
    v_exp_f32 v77, v77
    v_exp_f32 v78, v78
    v_exp_f32 v79, v79
    v_cvt_pk_bf16_f32 v36, v72, v73
    v_cvt_pk_bf16_f32 v37, v74, v75
    v_cvt_pk_bf16_f32 v38, v76, v77
    v_cvt_pk_bf16_f32 v39, v78, v79
    s_cmp_eq_u32 s61, 2
    s_waitcnt lgkmcnt(0)
    v_mfma_f32_32x32x16_bf16 v[128:143], v[236:239], v[36:39], v[128:143]
    s_cbranch_scc1 att_done
    s_setprio 2
    v_mfma_f32_32x32x16_bf16 v[64:79], v[144:147], v[20:23], v[112:127]
    ds_read_b128 v[148:151], v8 offset:16384
    s_mov_b64 exec, s[12:13]
    ds_read_b128 v[216:219], v9 offset:22528
    ds_read_b128 v[220:223], v9 offset:23552
    s_mov_b64 exec, -1
    s_add_u32 m0, s75, s8
    s_lshl_b32 s9, s75, 3
    buffer_load_dwordx4 v13, s[68:71], s9 offen lds
    s_add_u32 s75, s75, 1024
    v_exp_f32 v80, v80
    v_exp_f32 v81, v81
    v_exp_f32 v82, v82
    v_exp_f32 v83, v83
    v_exp_f32 v84, v84
    v_exp_f32 v85, v85
    v_exp_f32 v86, v86
    v_exp_f32 v87, v87
    v_cvt_pk_bf16_f32 v40, v80, v81
    v_cvt_pk_bf16_f32 v41, v82, v83
    v_cvt_pk_bf16_f32 v42, v84, v85
    v_cvt_pk_bf16_f32 v43, v86, v87
    v_exp_f32 v88, v88
    v_exp_f32 v89, v89
    v_mfma_f32_32x32x16_bf16 v[128:143], v[240:243], v[40:43], v[128:143]
    s_add_u32 m0, s75, s8
    s_lshl_b32 s9, s75, 3
    buffer_load_dwordx4 v13, s[68:71], s9 offen lds
    s_add_u32 s75, s75, 1024
    v_exp_f32 v90, v90
    v_exp_f32 v91, v91
    v_exp_f32 v92, v92
    v_exp_f32 v93, v93
    v_exp_f32 v94, v94
    v_exp_f32 v95, v95
    v_cvt_pk_bf16_f32 v44, v88, v89
    v_cvt_pk_bf16_f32 v45, v90, v91
    v_cvt_pk_bf16_f32 v46, v92, v93
    v_cvt_pk_bf16_f32 v47, v94, v95
    s_cmp_eq_u32 s61, 3
    s_waitcnt lgkmcnt(0)
    v_mfma_f32_32x32x16_bf16 v[128:143], v[244:247], v[44:47], v[128:143]
    s_cbranch_scc1 att_done
    v_mfma_f32_32x32x16_bf16 v[80:95], v[148:151], v[20:23], v[112:127]
    ds_read_b128 v[152:155], v8 offset:12288
    s_mov_b64 exec, s[12:13]
    ds_read_b128 v[224:227], v9 offset:18432
    ds_read_b128 v[228:231], v9 offset:19456
    s_mov_b64 exec, -1
    s_add_u32 m0, s75, s8
    s_lshl_b32 s9, s75, 3
    buffer_load_dwordx4 v13, s[68:71], s9 offen lds
    s_add_u32 s75, s75, 1024
    v_exp_f32 v64, v64
    v_exp_f32 v65, v65
    v_exp_f32 v66, v66
    v_exp_f32 v67, v67
    v_exp_f32 v68, v68
    v_exp_f32 v69, v69
    v_exp_f32 v70, v70
    v_exp_f32 v71, v71
    v_cvt_pk_bf16_f32 v32, v64, v65
    v_cvt_pk_bf16_f32 v33, v66, v67
    v_cvt_pk_bf16_f32 v34, v68, v69
    v_cvt_pk_bf16_f32 v35, v70, v71
    v_exp_f32 v72, v72
    v_exp_f32 v73, v73
    v_mfma_f32_32x32x16_bf16 v[128:143], v[216:219], v[32:35], v[128:143]
    s_add_u32 m0, s75, s8
    s_lshl_b32 s9, s75, 3
    buffer_load_dwordx4 v13, s[68:71], s9 offen lds
    s_add_u32 s75, s75, 1024
    v_exp_f32 v74, v74
    v_exp_f32 v75, v75
    v_exp_f32 v76, v76
    v_exp_f32 v77, v77
    v_exp_f32 v78, v78
    v_exp_f32 v79, v79
    v_cvt_pk_bf16_f32 v36, v72, v73
    v_cvt_pk_bf16_f32 v37, v74, v75
    v_cvt_pk_bf16_f32 v38, v76, v77
    v_cvt_pk_bf16_f32 v39, v78, v79
    s_cmp_eq_u32 s61, 4
    s_waitcnt lgkmcnt(0)
    v_mfma_f32_32x32x16_bf16 v[128:143], v[220:223], v[36:39], v[128:143]
    s_cbranch_scc1 att_done
    s_setprio 1
    v_mfma_f32_32x32x16_bf16 v[64:79], v[152:155], v[20:23], v[112:127]
    ds_read_b128 v[156:159], v8 offset:8192
    s_mov_b64 exec, s[12:13]
    ds_read_b128 v[232:235], v9 offset:14336
    ds_read_b128 v[236:239], v9 offset:15360
    s_mov_b64 exec, -1
    v_exp_f32 v80, v80
    v_exp_f32 v81, v81
    v_exp_f32 v82, v82
    v_exp_f32 v83, v83
    v_exp_f32 v84, v84
    v_exp_f32 v85, v85
    v_exp_f32 v86, v86
    v_exp_f32 v87, v87
    v_cvt_pk_bf16_f32 v40, v80, v81
    v_cvt_pk_bf16_f32 v41, v82, v83
    v_cvt_pk_bf16_f32 v42, v84, v85
    v_cvt_pk_bf16_f32 v43, v86, v87
    v_exp_f32 v88, v88
    v_exp_f32 v89, v89
    v_mfma_f32_32x32x16_bf16 v[128:143], v[224:227], v[40:43], v[128:143]
    s_add_u32 m0, s75, s8
    s_lshl_b32 s9, s75, 3
    buffer_load_dwordx4 v13, s[68:71], s9 offen lds
    s_add_u32 s75, s75, 1024
    v_exp_f32 v90, v90
    v_exp_f32 v91, v91
    v_exp_f32 v92, v92
    v_exp_f32 v93, v93
    v_exp_f32 v94, v94
    v_exp_f32 v95, v95
    v_cvt_pk_bf16_f32 v44, v88, v89
    v_cvt_pk_bf16_f32 v45, v90, v91
    v_cvt_pk_bf16_f32 v46, v92, v93
    v_cvt_pk_bf16_f32 v47, v94, v95
    s_cmp_eq_u32 s61, 5
    s_waitcnt lgkmcnt(0)
    v_mfma_f32_32x32x16_bf16 v[128:143], v[228:231], v[44:47], v[128:143]
    s_cbranch_scc1 att_done
    v_mfma_f32_32x32x16_bf16 v[80:95], v[156:159], v[20:23], v[112:127]
    ds_read_b128 v[144:147], v8 offset:4096
    s_mov_b64 exec, s[12:13]
    ds_read_b128 v[240:243], v9 offset:10240
    ds_read_b128 v[244:247], v9 offset:11264
    s_mov_b64 exec, -1
    v_exp_f32 v64, v64
    v_exp_f32 v65, v65
    v_exp_f32 v66, v66
    v_exp_f32 v67, v67
    v_exp_f32 v68, v68
    v_exp_f32 v69, v69
    v_exp_f32 v70, v70
    v_exp_f32 v71, v71
    v_cvt_pk_bf16_f32 v32, v64, v65
    v_cvt_pk_bf16_f32 v33, v66, v67
    v_cvt_pk_bf16_f32 v34, v68, v69
    v_cvt_pk_bf16_f32 v35, v70, v71
    v_exp_f32 v72, v72
    v_exp_f32 v73, v73
    v_mfma_f32_32x32x16_bf16 v[128:143], v[232:235], v[32:35], v[128:143]
    v_exp_f32 v74, v74
    v_exp_f32 v75, v75
    v_exp_f32 v76, v76
    v_exp_f32 v77, v77
    v_exp_f32 v78, v78
    v_exp_f32 v79, v79
    v_cvt_pk_bf16_f32 v36, v72, v73
    v_cvt_pk_bf16_f32 v37, v74, v75
    v_cvt_pk_bf16_f32 v38, v76, v77
    v_cvt_pk_bf16_f32 v39, v78, v79
    s_cmp_eq_u32 s61, 6
    s_waitcnt lgkmcnt(0)
    v_mfma_f32_32x32x16_bf16 v[128:143], v[236:239], v[36:39], v[128:143]
    s_cbranch_scc1 att_done
    s_setprio 0
    v_mfma_f32_32x32x16_bf16 v[64:79], v[144:147], v[20:23], v[112:127]
    s_mov_b64 exec, s[12:13]
    ds_read_b128 v[216:219], v9 offset:6144
    ds_read_b128 v[220:223], v9 offset:7168
    s_mov_b64 exec, -1
    v_exp_f32 v80, v80
    v_exp_f32 v81, v81
    v_exp_f32 v82, v82
    v_exp_f32 v83, v83
    v_exp_f32 v84, v84
    v_exp_f32 v85, v85
    v_exp_f32 v86, v86
    v_exp_f32 v87, v87
    v_cvt_pk_bf16_f32 v40, v80, v81
    v_cvt_pk_bf16_f32 v41, v82, v83
    v_cvt_pk_bf16_f32 v42, v84, v85
    v_cvt_pk_bf16_f32 v43, v86, v87
    v_exp_f32 v88, v88
    v_exp_f32 v89, v89
    v_mfma_f32_32x32x16_bf16 v[128:143], v[240:243], v[40:43], v[128:143]
    v_exp_f32 v90, v90
    v_exp_f32 v91, v91
    v_exp_f32 v92, v92
    v_exp_f32 v93, v93
    v_exp_f32 v94, v94
    v_exp_f32 v95, v95
    v_cvt_pk_bf16_f32 v44, v88, v89
    v_cvt_pk_bf16_f32 v45, v90, v91
    v_cvt_pk_bf16_f32 v46, v92, v93
    v_cvt_pk_bf16_f32 v47, v94, v95
    s_cmp_eq_u32 s61, 7
    s_waitcnt lgkmcnt(0)
    v_mfma_f32_32x32x16_bf16 v[128:143], v[244:247], v[44:47], v[128:143]
    s_cbranch_scc1 att_done
    v_exp_f32 v64, v64
    v_exp_f32 v65, v65
    v_exp_f32 v66, v66
    v_exp_f32 v67, v67
    v_exp_f32 v68, v68
    v_exp_f32 v69, v69
    v_exp_f32 v70, v70
    v_exp_f32 v71, v71
    v_cvt_pk_bf16_f32 v32, v64, v65
    v_cvt_pk_bf16_f32 v33, v66, v67
    v_cvt_pk_bf16_f32 v34, v68, v69
    v_cvt_pk_bf16_f32 v35, v70, v71
    v_exp_f32 v72, v72
    v_exp_f32 v73, v73
    v_mfma_f32_32x32x16_bf16 v[128:143], v[216:219], v[32:35], v[128:143]
    v_exp_f32 v74, v74
    v_exp_f32 v75, v75
    v_exp_f32 v76, v76
    v_exp_f32 v77, v77
    v_exp_f32 v78, v78
    v_exp_f32 v79, v79
    v_cvt_pk_bf16_f32 v36, v72, v73
    v_cvt_pk_bf16_f32 v37, v74, v75
    v_cvt_pk_bf16_f32 v38, v76, v77
    v_cvt_pk_bf16_f32 v39, v78, v79
    s_cmp_eq_u32 s61, 8
    s_waitcnt lgkmcnt(0)
    v_mfma_f32_32x32x16_bf16 v[128:143], v[220:223], v[36:39], v[128:143]
att_done:
    s_nop 0
    s_mov_b32 s14, 0x6c800000
    v_mov_b32 v6, 0
    s_lshl_b32 s101, s3, 3
    s_bfe_u32 s9, s4, 0x10003
    s_lshl_b32 s9, s9, 2
    s_add_u32 s101, s101, s9
    s_and_b32 s9, s7, 3
    s_add_u32 s101, s101, s9
    s_lshl_b32 s101, s101, 8
    s_add_u32 s101, s101, 11534336
    s_nop 0
    v_rcp_f32 v4, v136
    v_mov_b32 v7, v136
    v_fmac_f32 v7, v128, v6
    v_fmac_f32 v7, v129, v6
    v_fmac_f32 v7, v130, v6
    v_fmac_f32 v7, v131, v6
    v_fmac_f32 v7, v132, v6
    v_fmac_f32 v7, v133, v6
    v_fmac_f32 v7, v134, v6
    v_fmac_f32 v7, v135, v6
    v_fmamk_f32 v7, v4, 0x58800000, v7
    v_cmp_nge_f32 vcc, s14, v7
    s_cbranch_vccnz att_fb
att_fin:
    v_mul_f32 v128, v128, v4
    v_mul_f32 v129, v129, v4
    v_mul_f32 v130, v130, v4
    v_mul_f32 v131, v131, v4
    v_mul_f32 v132, v132, v4
    v_mul_f32 v133, v133, v4
    v_mul_f32 v134, v134, v4
    v_mul_f32 v135, v135, v4
    v_cvt_pk_bf16_f32 v32, v128, v129
    v_cvt_pk_bf16_f32 v33, v130, v131
    v_cvt_pk_bf16_f32 v34, v132, v133
    v_cvt_pk_bf16_f32 v35, v134, v135
    ds_write_b128 v10, v[32:35]
att_wo:
    s_cmp_ge_u32 s75, 8192
    s_cbranch_scc1 att_wo2
    s_add_u32 m0, s75, s8
    s_lshl_b32 s9, s75, 3
    buffer_load_dwordx4 v13, s[68:71], s9 offen lds
    s_add_u32 s75, s75, 1024
    s_branch att_wo
att_wo2:
    s_setprio 0
    v_mov_b32 v4, 1
    s_waitcnt vmcnt(0)
    s_cmp_lt_u32 s3, 4
    s_cbranch_scc0 att_nt
    s_mov_b32 exec_hi, 0
    buffer_load_dwordx4 v[24:27], v18, s[48:51], s79 offen sc1
    s_mov_b64 exec, -1
att_nt:
    s_waitcnt lgkmcnt(0)
    s_barrier
    ds_read_b128 v[32:35], v11
    s_waitcnt lgkmcnt(0)
    buffer_store_dwordx4 v[32:35], v12, s[48:51], s62 offen sc1
    s_cmp_lt_u32 s3, 4
    s_cbranch_scc1 out_comp
    s_sub_u32 s60, s3, 4
    s_lshr_b32 s9, s72, 1
    s_lshl_b32 s9, s9, 3
    s_lshl_b32 s10, s73, 2
    s_add_u32 s9, s9, s10
    s_add_u32 s9, s9, s60
    s_lshl_b32 s9, s9, 8
    s_add_u32 s9, s9, 11534336
    s_mul_i32 s8, s72, 132096
    s_lshl_b32 s10, s73, 16
    s_add_u32 s8, s8, s10
    s_lshl_b32 s10, s60, 12
    s_add_u32 s8, s8, s10
    s_add_u32 s8, s8, 7340032
    s_mov_b32 s15, 0
    s_waitcnt vmcnt(0)
    s_mov_b64 exec, 1
    buffer_atomic_add v4, off, s[48:51], s101 sc1
    s_mov_b64 exec, -1
    s_mov_b64 exec, 1
o_poll:
    v_mov_b32 v6, 0
    buffer_atomic_add v6, off, s[48:51], s9 sc0 sc1
    s_add_u32 s15, s15, 1
    s_waitcnt vmcnt(0)
    v_cmp_gt_u32 vcc, 32, v6
    s_cmp_gt_u32 s15, 0x40000
    s_cbranch_scc1 o_polled
    s_cbranch_vccz o_polled
    s_sleep 0
    s_branch o_poll
o_polled:
    s_mov_b64 exec, -1
    s_add_u32 m0, s10, 32768
    s_nop 0
    buffer_load_dwordx4 v14, s[48:51], s8 offen offset:0 sc1 lds
    buffer_load_dwordx4 v14, s[48:51], s8 offen offset:1024 sc1 lds
    buffer_load_dwordx4 v14, s[48:51], s8 offen offset:2048 sc1 lds
    buffer_load_dwordx4 v14, s[48:51], s8 offen offset:3072 sc1 lds
    s_add_u32 m0, s10, 49152
    s_add_u32 s8, s8, 16384
    buffer_load_dwordx4 v14, s[48:51], s8 offen offset:0 sc1 lds
    buffer_load_dwordx4 v14, s[48:51], s8 offen offset:1024 sc1 lds
    buffer_load_dwordx4 v14, s[48:51], s8 offen offset:2048 sc1 lds
    buffer_load_dwordx4 v14, s[48:51], s8 offen offset:3072 sc1 lds
    s_waitcnt vmcnt(4)
    s_barrier
    s_add_u32 m0, s10, 65536
    s_add_u32 s8, s8, 16384
    buffer_load_dwordx4 v14, s[48:51], s8 offen offset:0 sc1 lds
    buffer_load_dwordx4 v14, s[48:51], s8 offen offset:1024 sc1 lds
    buffer_load_dwordx4 v14, s[48:51], s8 offen offset:2048 sc1 lds
    buffer_load_dwordx4 v14, s[48:51], s8 offen offset:3072 sc1 lds
    s_waitcnt vmcnt(4)
    s_barrier
    s_add_u32 m0, s10, 81920
    s_add_u32 s8, s8, 16384
    buffer_load_dwordx4 v14, s[48:51], s8 offen offset:0 sc1 lds
    buffer_load_dwordx4 v14, s[48:51], s8 offen offset:1024 sc1 lds
    buffer_load_dwordx4 v14, s[48:51], s8 offen offset:2048 sc1 lds
    buffer_load_dwordx4 v14, s[48:51], s8 offen offset:3072 sc1 lds
    s_waitcnt vmcnt(4)
    s_barrier
    s_waitcnt vmcnt(0)
    s_barrier
    s_endpgm
out_comp:
    s_lshr_b32 s66, s3, 1
    s_and_b32 s67, s3, 1
    s_mov_b32 s68, s34
    s_mov_b32 s69, s35
    s_mov_b32 s70, 2097152
    s_mov_b32 s71, 0x00020000
    v_and_b32 v1, 31, v0
    v_lshrrev_b32 v2, 5, v0
    s_lshl_b32 s9, s67, 5
    s_lshl_b32 s10, s73, 6
    s_add_u32 s9, s9, s10
    v_add_u32 v3, s9, v1
    v_bfe_u32 v9, v0, 3, 2
    v_lshlrev_b32 v6, 9, v9
    v_and_b32 v9, 1, v9
    v_xor_b32 v9, v9, v2
    v_lshl_add_u32 v6, v9, 7, v6
    v_and_b32 v9, 7, v0
    v_lshl_add_u32 v6, v9, 4, v6
    s_lshl_b32 s9, s67, 11
    s_add_u32 s9, s9, 32768
    v_add_u32 v6, s9, v6
    v_bfe_u32 v9, v0, 2, 2
    v_lshl_add_u32 v7, v2, 2, v9
    v_lshlrev_b32 v7, 7, v7
    v_lshrrev_b32 v9, 1, v9
    v_xor_b32 v9, s66, v9
    v_lshl_add_u32 v7, v9, 6, v7
    v_and_b32 v9, 1, v0
    v_lshl_add_u32 v7, v9, 5, v7
    v_bfe_u32 v9, v0, 4, 1
    v_lshl_add_u32 v7, v9, 4, v7
    v_bfe_u32 v9, v0, 1, 1
    v_lshl_add_u32 v7, v9, 3, v7
    v_add_u32 v7, 98304, v7
    v_bfe_u32 v9, v0, 2, 1
    v_lshlrev_b32 v8, 4, v9
    v_and_b32 v9, 3, v0
    v_add_u32 v8, v8, v9
    v_bfe_u32 v9, v0, 3, 2
    v_lshl_add_u32 v8, v9, 2, v8
    s_lshl_b32 s9, s66, 5
    s_lshl_b32 s10, s74, 6
    s_add_u32 s9, s9, s10
    v_add_u32 v8, s9, v8
    v_sub_u32 v9, 512, v8
    s_sub_u32 s12, 16, s72
    s_and_b32 s12, s12, 15
    s_cmp_ge_u32 s74, 4
    s_cselect_b32 s12, s12, s72
    s_cselect_b32 s13, -1, 0
    v_bfi_b32 v8, s13, v9, v8
    v_lshlrev_b32 v8, 4, v8
    v_mul_u32_u24 v9, 4224, v2
    v_add_u32 v8, v8, v9
    s_lshl_b32 s12, s12, 1
    s_add_u32 s12, s12, s67
    s_mul_i32 s12, s12, 67584
    s_add_u32 s12, s12, 4194304
    s_lshl_b32 s9, s3, 12
    v_add_u32 v29, s9, v14
    v_xor_b32 v30, 4096, v29
    v_lshlrev_b32 v28, 14, v3
    v_lshl_add_u32 v28, v2, 5, v28
    s_lshl_b32 s14, s72, 10
    s_lshl_b32 s10, s74, 7
    s_add_u32 s14, s14, s10
    s_lshl_b32 s10, s66, 6
    s_add_u32 s14, s14, s10
    v_lshlrev_b32 v5, 2, v3
    s_lshl_b32 s11, s72, 9
    s_add_u32 s11, s11, 10485760
    s_mov_b32 s15, 0
    s_cmp_eq_u32 s72, 0
    s_cselect_b32 s9, 1, 0
    s_add_u32 s9, s9, 127
    s_lshl_b32 s10, s67, 4
    v_add_u32 v15, s10, v2
    v_cvt_f32_u32 v15, v15
    v_mul_f32 v15, 4.0, v15
    s_sub_u32 s77, 0, s67
    s_xor_b32 s77, s77, s13
    s_and_b32 s77, s77, 0x80008000
    v_sub_u32 v10, s9, v3
    v_and_b32 v10, 127, v10
    v_bfi_b32 v10, s13, v10, v3
    v_cvt_f32_u32 v10, v10
    v_mul_f32 v10, 0x3c000000, v10
    v_mul_f32 v11, v15, v10
    v_mul_f32 v12, 0x41000000, v10
    v_cos_f32 v12, v12
    s_nop 0
    v_add_f32 v12, v12, v12
    v_fmamk_f32 v13, v10, 0x00000000, v11
    v_cos_f32 v112, v13
    v_sin_f32 v113, v13
    s_nop 0
    v_cvt_pk_bf16_f32 v160, v112, v113
    v_mov_b32 v96, v160
    v_fmamk_f32 v13, v10, 0x3f800000, v11
    v_cos_f32 v114, v13
    v_sin_f32 v115, v13
    s_nop 0
    v_cvt_pk_bf16_f32 v161, v114, v115
    v_cvt_pk_bf16_f32 v97, -v115, v114
    v_xor_b32 v97, s77, v97
    ds_read_b64_tr_b16 v[128:129], v7 offset:16384
    ds_read_b64_tr_b16 v[130:131], v7 offset:17408
    v_fmamk_f32 v13, v10, 0x40000000, v11
    v_cos_f32 v116, v13
    v_sin_f32 v117, v13
    s_nop 0
    v_cvt_pk_bf16_f32 v162, v116, v117
    v_xor_b32 v98, 0x80008000, v162
    v_fmamk_f32 v13, v10, 0x40400000, v11
    v_cos_f32 v118, v13
    v_sin_f32 v119, v13
    s_nop 0
    v_cvt_pk_bf16_f32 v163, v118, v119
    v_cvt_pk_bf16_f32 v99, v119, -v118
    v_xor_b32 v99, s77, v99
    ds_read_b64_tr_b16 v[132:133], v7 offset:18432
    ds_read_b64_tr_b16 v[134:135], v7 offset:19456
    v_fmamk_f32 v13, v10, 0x41000000, v11
    v_cos_f32 v120, v13
    v_sin_f32 v121, v13
    s_nop 0
    v_cvt_pk_bf16_f32 v164, v120, v121
    v_mov_b32 v100, v164
    v_fmamk_f32 v13, v10, 0x41100000, v11
    v_cos_f32 v122, v13
    v_sin_f32 v123, v13
    s_nop 0
    v_cvt_pk_bf16_f32 v165, v122, v123
    v_cvt_pk_bf16_f32 v101, -v123, v122
    v_xor_b32 v101, s77, v101
    ds_read_b64_tr_b16 v[136:137], v7 offset:20480
    ds_read_b64_tr_b16 v[138:139], v7 offset:21504
    v_fmamk_f32 v13, v10, 0x41200000, v11
    v_cos_f32 v124, v13
    v_sin_f32 v125, v13
    s_nop 0
    v_cvt_pk_bf16_f32 v166, v124, v125
    s_waitcnt vmcnt(0)
    s_mov_b64 exec, 1
    buffer_atomic_add v4, off, s[48:51], s101 sc1
    s_mov_b64 exec, -1
t_poll:
    s_mov_b32 exec_hi, 0
    v_xor_b32 v24, s63, v24
    v_xor_b32 v25, s63, v25
    v_xor_b32 v26, s63, v26
    v_xor_b32 v27, s63, v27
    v_or3_b32 v24, v24, v25, v26
    v_or_b32 v24, v24, v27
    v_cmp_ne_u32 vcc, 0, v24
    s_mov_b64 exec, -1
    s_add_u32 s15, s15, 1
    s_cmp_gt_u32 s15, 0x40000
    s_cbranch_scc1 t_polled
    s_cbranch_vccz t_polled
    s_sleep 8
    s_mov_b32 exec_hi, 0
    buffer_load_dwordx4 v[24:27], v18, s[48:51], s79 offen sc1
    s_mov_b64 exec, -1
    s_waitcnt vmcnt(0)
    s_branch t_poll
t_polled:
    buffer_load_dwordx4 v[192:195], v8, s[48:51], s12 offen sc1
    s_add_u32 s12, s12, 8448
    buffer_load_dwordx4 v[196:199], v8, s[48:51], s12 offen sc1
    s_add_u32 s12, s12, 8448
    buffer_load_dwordx4 v[200:203], v8, s[48:51], s12 offen sc1
    s_add_u32 s12, s12, 8448
    buffer_load_dwordx4 v[204:207], v8, s[48:51], s12 offen sc1
    s_add_u32 s12, s12, 8448
    buffer_load_dwordx4 v[208:211], v8, s[48:51], s12 offen sc1
    s_add_u32 s12, s12, 8448
    buffer_load_dwordx4 v[212:215], v8, s[48:51], s12 offen sc1
    s_add_u32 s12, s12, 8448
    buffer_load_dwordx4 v[216:219], v8, s[48:51], s12 offen sc1
    s_add_u32 s12, s12, 8448
    buffer_load_dwordx4 v[220:223], v8, s[48:51], s12 offen sc1
    v_xor_b32 v102, 0x80008000, v166
    v_fmamk_f32 v13, v10, 0x41300000, v11
    v_cos_f32 v126, v13
    v_sin_f32 v127, v13
    s_nop 0
    v_cvt_pk_bf16_f32 v167, v126, v127
    v_cvt_pk_bf16_f32 v103, v127, -v126
    v_xor_b32 v103, s77, v103
    ds_read_b64_tr_b16 v[140:141], v7 offset:22528
    ds_read_b64_tr_b16 v[142:143], v7 offset:23552
    v_fma_f32 v112, v12, v120, -v112
    v_fma_f32 v113, v12, v121, -v113
    v_cvt_pk_bf16_f32 v168, v112, v113
    v_mov_b32 v104, v168
    v_fma_f32 v114, v12, v122, -v114
    v_fma_f32 v115, v12, v123, -v115
    v_cvt_pk_bf16_f32 v169, v114, v115
    v_cvt_pk_bf16_f32 v105, -v115, v114
    v_xor_b32 v105, s77, v105
    ds_read_b64_tr_b16 v[144:145], v7 offset:24576
    ds_read_b64_tr_b16 v[146:147], v7 offset:25600
    v_fma_f32 v116, v12, v124, -v116
    v_fma_f32 v117, v12, v125, -v117
    v_cvt_pk_bf16_f32 v170, v116, v117
    v_xor_b32 v106, 0x80008000, v170
    v_fma_f32 v118, v12, v126, -v118
    v_fma_f32 v119, v12, v127, -v119
    v_cvt_pk_bf16_f32 v171, v118, v119
    v_cvt_pk_bf16_f32 v107, v119, -v118
    v_xor_b32 v107, s77, v107
    ds_read_b64_tr_b16 v[148:149], v7 offset:26624
    ds_read_b64_tr_b16 v[150:151], v7 offset:27648
    v_fma_f32 v120, v12, v112, -v120
    v_fma_f32 v121, v12, v113, -v121
    v_cvt_pk_bf16_f32 v172, v120, v121
    v_mov_b32 v108, v172
    v_fma_f32 v122, v12, v114, -v122
    v_fma_f32 v123, v12, v115, -v123
    v_cvt_pk_bf16_f32 v173, v122, v123
    v_cvt_pk_bf16_f32 v109, -v123, v122
    v_xor_b32 v109, s77, v109
    ds_read_b64_tr_b16 v[152:153], v7 offset:28672
    ds_read_b64_tr_b16 v[154:155], v7 offset:29696
    v_fma_f32 v124, v12, v116, -v124
    v_fma_f32 v125, v12, v117, -v125
    v_cvt_pk_bf16_f32 v174, v124, v125
    v_xor_b32 v110, 0x80008000, v174
    v_fma_f32 v126, v12, v118, -v126
    v_fma_f32 v127, v12, v119, -v127
    v_cvt_pk_bf16_f32 v175, v126, v127
    v_cvt_pk_bf16_f32 v111, v127, -v126
    v_xor_b32 v111, s77, v111
    ds_read_b64_tr_b16 v[156:157], v7 offset:30720
    ds_read_b64_tr_b16 v[158:159], v7 offset:31744
    v_fma_f32 v112, v12, v120, -v112
    v_fma_f32 v113, v12, v121, -v113
    v_cvt_pk_bf16_f32 v176, v112, v113
    v_mov_b32 v48, v176
    v_fma_f32 v114, v12, v122, -v114
    v_fma_f32 v115, v12, v123, -v115
    v_cvt_pk_bf16_f32 v177, v114, v115
    v_cvt_pk_bf16_f32 v49, -v115, v114
    v_xor_b32 v49, s77, v49
    ds_read_b64_tr_b16 v[36:37], v7 offset:51200
    ds_read_b64_tr_b16 v[38:39], v7 offset:52224
    v_fma_f32 v116, v12, v124, -v116
    v_fma_f32 v117, v12, v125, -v117
    v_cvt_pk_bf16_f32 v178, v116, v117
    v_xor_b32 v50, 0x80008000, v178
    v_fma_f32 v118, v12, v126, -v118
    v_fma_f32 v119, v12, v127, -v119
    v_cvt_pk_bf16_f32 v179, v118, v119
    v_cvt_pk_bf16_f32 v51, v119, -v118
    v_xor_b32 v51, s77, v51
    ds_read_b64_tr_b16 v[40:41], v7 offset:53248
    ds_read_b64_tr_b16 v[42:43], v7 offset:54272
    v_fma_f32 v120, v12, v112, -v120
    v_fma_f32 v121, v12, v113, -v121
    v_cvt_pk_bf16_f32 v180, v120, v121
    v_mov_b32 v52, v180
    v_fma_f32 v122, v12, v114, -v122
    v_fma_f32 v123, v12, v115, -v123
    v_cvt_pk_bf16_f32 v181, v122, v123
    v_cvt_pk_bf16_f32 v53, -v123, v122
    v_xor_b32 v53, s77, v53
    ds_read_b64_tr_b16 v[44:45], v7 offset:55296
    ds_read_b64_tr_b16 v[46:47], v7 offset:56320
    v_fma_f32 v124, v12, v116, -v124
    v_fma_f32 v125, v12, v117, -v125
    v_cvt_pk_bf16_f32 v182, v124, v125
    v_xor_b32 v54, 0x80008000, v182
    v_fma_f32 v126, v12, v118, -v126
    v_fma_f32 v127, v12, v119, -v127
    v_cvt_pk_bf16_f32 v183, v126, v127
    v_cvt_pk_bf16_f32 v55, v127, -v126
    v_xor_b32 v55, s77, v55
    v_fma_f32 v112, v12, v120, -v112
    v_fma_f32 v113, v12, v121, -v113
    v_cvt_pk_bf16_f32 v184, v112, v113
    v_mov_b32 v56, v184
    v_fma_f32 v114, v12, v122, -v114
    v_fma_f32 v115, v12, v123, -v115
    v_cvt_pk_bf16_f32 v185, v114, v115
    v_cvt_pk_bf16_f32 v57, -v115, v114
    v_xor_b32 v57, s77, v57
    v_fma_f32 v116, v12, v124, -v116
    v_fma_f32 v117, v12, v125, -v117
    v_cvt_pk_bf16_f32 v186, v116, v117
    v_xor_b32 v58, 0x80008000, v186
    v_fma_f32 v118, v12, v126, -v118
    v_fma_f32 v119, v12, v127, -v119
    v_cvt_pk_bf16_f32 v187, v118, v119
    v_cvt_pk_bf16_f32 v59, v119, -v118
    v_xor_b32 v59, s77, v59
    v_fma_f32 v120, v12, v112, -v120
    v_fma_f32 v121, v12, v113, -v121
    v_cvt_pk_bf16_f32 v188, v120, v121
    v_mov_b32 v60, v188
    v_fma_f32 v122, v12, v114, -v122
    v_fma_f32 v123, v12, v115, -v123
    v_cvt_pk_bf16_f32 v189, v122, v123
    v_cvt_pk_bf16_f32 v61, -v123, v122
    v_xor_b32 v61, s77, v61
    v_fma_f32 v124, v12, v116, -v124
    v_fma_f32 v125, v12, v117, -v125
    v_cvt_pk_bf16_f32 v190, v124, v125
    v_xor_b32 v62, 0x80008000, v190
    v_fma_f32 v126, v12, v118, -v126
    v_fma_f32 v127, v12, v119, -v127
    v_cvt_pk_bf16_f32 v191, v126, v127
    v_cvt_pk_bf16_f32 v63, v127, -v126
    v_xor_b32 v63, s77, v63
    s_waitcnt vmcnt(7)
    v_mfma_f32_32x32x16_bf16 v[224:239], v[192:195], v[96:99], 0
    v_mfma_f32_32x32x16_bf16 v[80:95], v[192:195], v[160:163], 0
    s_waitcnt vmcnt(6)
    v_mfma_f32_32x32x16_bf16 v[224:239], v[196:199], v[100:103], v[224:239]
    v_mfma_f32_32x32x16_bf16 v[80:95], v[196:199], v[164:167], v[80:95]
    s_waitcnt vmcnt(5)
    v_mfma_f32_32x32x16_bf16 v[224:239], v[200:203], v[104:107], v[224:239]
    v_mfma_f32_32x32x16_bf16 v[80:95], v[200:203], v[168:171], v[80:95]
    s_waitcnt vmcnt(4)
    v_mfma_f32_32x32x16_bf16 v[224:239], v[204:207], v[108:111], v[224:239]
    v_mfma_f32_32x32x16_bf16 v[80:95], v[204:207], v[172:175], v[80:95]
    s_waitcnt vmcnt(3)
    v_mfma_f32_32x32x16_bf16 v[224:239], v[208:211], v[48:51], v[224:239]
    v_mfma_f32_32x32x16_bf16 v[80:95], v[208:211], v[176:179], v[80:95]
    s_waitcnt vmcnt(2)
    v_mfma_f32_32x32x16_bf16 v[224:239], v[212:215], v[52:55], v[224:239]
    v_mfma_f32_32x32x16_bf16 v[80:95], v[212:215], v[180:183], v[80:95]
    s_waitcnt vmcnt(1)
    v_mfma_f32_32x32x16_bf16 v[224:239], v[216:219], v[56:59], v[224:239]
    v_mfma_f32_32x32x16_bf16 v[80:95], v[216:219], v[184:187], v[80:95]
    s_waitcnt vmcnt(0)
    v_mfma_f32_32x32x16_bf16 v[224:239], v[220:223], v[60:63], v[224:239]
    v_mfma_f32_32x32x16_bf16 v[80:95], v[220:223], v[188:191], v[80:95]
    ds_read_b64_tr_b16 v[96:97], v7 offset:0
    ds_read_b64_tr_b16 v[98:99], v7 offset:1024
    ds_read_b64_tr_b16 v[100:101], v7 offset:2048
    ds_read_b64_tr_b16 v[102:103], v7 offset:3072
    ds_read_b64_tr_b16 v[104:105], v7 offset:4096
    ds_read_b64_tr_b16 v[106:107], v7 offset:5120
    ds_read_b64_tr_b16 v[108:109], v7 offset:6144
    ds_read_b64_tr_b16 v[110:111], v7 offset:7168
    ds_read_b64_tr_b16 v[112:113], v7 offset:8192
    ds_read_b64_tr_b16 v[114:115], v7 offset:9216
    ds_read_b64_tr_b16 v[116:117], v7 offset:10240
    ds_read_b64_tr_b16 v[118:119], v7 offset:11264
    ds_read_b64_tr_b16 v[120:121], v7 offset:12288
    ds_read_b64_tr_b16 v[122:123], v7 offset:13312
    ds_read_b64_tr_b16 v[124:125], v7 offset:14336
    ds_read_b64_tr_b16 v[126:127], v7 offset:15360
    ds_read_b64_tr_b16 v[160:161], v7 offset:32768
    ds_read_b64_tr_b16 v[162:163], v7 offset:33792
    ds_read_b64_tr_b16 v[164:165], v7 offset:34816
    ds_read_b64_tr_b16 v[166:167], v7 offset:35840
    ds_read_b64_tr_b16 v[168:169], v7 offset:36864
    ds_read_b64_tr_b16 v[170:171], v7 offset:37888
    ds_read_b64_tr_b16 v[172:173], v7 offset:38912
    ds_read_b64_tr_b16 v[174:175], v7 offset:39936
    ds_read_b64_tr_b16 v[176:177], v7 offset:40960
    ds_read_b64_tr_b16 v[178:179], v7 offset:41984
    ds_read_b64_tr_b16 v[180:181], v7 offset:43008
    ds_read_b64_tr_b16 v[182:183], v7 offset:44032
    ds_read_b64_tr_b16 v[184:185], v7 offset:45056
    ds_read_b64_tr_b16 v[186:187], v7 offset:46080
    ds_read_b64_tr_b16 v[188:189], v7 offset:47104
    ds_read_b64_tr_b16 v[190:191], v7 offset:48128
    ds_read_b64_tr_b16 v[32:33], v7 offset:49152
    ds_read_b64_tr_b16 v[34:35], v7 offset:50176
    ds_read_b64_tr_b16 v[48:49], v7 offset:57344
    ds_read_b64_tr_b16 v[50:51], v7 offset:58368
    ds_read_b64_tr_b16 v[52:53], v7 offset:59392
    ds_read_b64_tr_b16 v[54:55], v7 offset:60416
    ds_read_b64_tr_b16 v[56:57], v7 offset:61440
    ds_read_b64_tr_b16 v[58:59], v7 offset:62464
    ds_read_b64_tr_b16 v[60:61], v7 offset:63488
    ds_read_b64_tr_b16 v[62:63], v7 offset:64512
    ds_write_b128 v29, v[224:227] offset:0
    ds_write_b128 v29, v[228:231] offset:1024
    ds_write_b128 v29, v[232:235] offset:2048
    ds_write_b128 v29, v[236:239] offset:3072
    s_waitcnt lgkmcnt(0)
    s_barrier
    ds_read_b128 v[192:195], v6 offset:0
    ds_read_b128 v[196:199], v6 offset:256
    ds_read_b128 v[200:203], v6 offset:4096
    ds_read_b128 v[204:207], v6 offset:4352
    ds_read_b128 v[208:211], v6 offset:8192
    ds_read_b128 v[212:215], v6 offset:8448
    ds_read_b128 v[216:219], v6 offset:12288
    ds_read_b128 v[220:223], v6 offset:12544
    buffer_load_dword v24, v5, s[48:51], s11 offen sc1
    s_waitcnt lgkmcnt(7)
    v_mfma_f32_32x32x16_bf16 v[64:79], v[96:99], v[192:195], 0
    s_waitcnt lgkmcnt(6)
    v_mfma_f32_32x32x16_bf16 v[64:79], v[100:103], v[196:199], v[64:79]
    s_waitcnt lgkmcnt(5)
    v_mfma_f32_32x32x16_bf16 v[64:79], v[104:107], v[200:203], v[64:79]
    s_waitcnt lgkmcnt(0)
    v_mfma_f32_32x32x16_bf16 v[64:79], v[108:111], v[204:207], v[64:79]
    s_barrier
    ds_read_b128 v[224:227], v6 offset:16384
    ds_read_b128 v[228:231], v6 offset:16640
    ds_read_b128 v[232:235], v6 offset:20480
    ds_read_b128 v[236:239], v6 offset:20736
    ds_read_b128 v[240:243], v6 offset:24576
    ds_read_b128 v[244:247], v6 offset:24832
    ds_read_b128 v[248:251], v6 offset:28672
    ds_read_b128 v[252:255], v6 offset:28928
    v_mfma_f32_32x32x16_bf16 v[64:79], v[112:115], v[208:211], v[64:79]
    v_mfma_f32_32x32x16_bf16 v[64:79], v[116:119], v[212:215], v[64:79]
    v_mfma_f32_32x32x16_bf16 v[64:79], v[120:123], v[216:219], v[64:79]
    v_mfma_f32_32x32x16_bf16 v[64:79], v[124:127], v[220:223], v[64:79]
    s_waitcnt lgkmcnt(7)
    v_mfma_f32_32x32x16_bf16 v[64:79], v[128:131], v[224:227], v[64:79]
    s_waitcnt lgkmcnt(6)
    v_mfma_f32_32x32x16_bf16 v[64:79], v[132:135], v[228:231], v[64:79]
    s_waitcnt lgkmcnt(5)
    v_mfma_f32_32x32x16_bf16 v[64:79], v[136:139], v[232:235], v[64:79]
    s_waitcnt lgkmcnt(0)
    v_mfma_f32_32x32x16_bf16 v[64:79], v[140:143], v[236:239], v[64:79]
    s_barrier
    ds_read_b128 v[96:99], v30 offset:0
    ds_read_b128 v[100:103], v30 offset:1024
    ds_read_b128 v[104:107], v30 offset:2048
    ds_read_b128 v[108:111], v30 offset:3072
    ds_read_b128 v[192:195], v6 offset:32768
    ds_read_b128 v[196:199], v6 offset:33024
    ds_read_b128 v[200:203], v6 offset:36864
    ds_read_b128 v[204:207], v6 offset:37120
    ds_read_b128 v[208:211], v6 offset:40960
    ds_read_b128 v[212:215], v6 offset:41216
    ds_read_b128 v[216:219], v6 offset:45056
    ds_read_b128 v[220:223], v6 offset:45312
    v_mfma_f32_32x32x16_bf16 v[64:79], v[144:147], v[240:243], v[64:79]
    v_mfma_f32_32x32x16_bf16 v[64:79], v[148:151], v[244:247], v[64:79]
    v_mfma_f32_32x32x16_bf16 v[64:79], v[152:155], v[248:251], v[64:79]
    v_mfma_f32_32x32x16_bf16 v[64:79], v[156:159], v[252:255], v[64:79]
    s_waitcnt lgkmcnt(7)
    v_mfma_f32_32x32x16_bf16 v[64:79], v[160:163], v[192:195], v[64:79]
    s_waitcnt lgkmcnt(6)
    v_mfma_f32_32x32x16_bf16 v[64:79], v[164:167], v[196:199], v[64:79]
    s_waitcnt lgkmcnt(5)
    v_mfma_f32_32x32x16_bf16 v[64:79], v[168:171], v[200:203], v[64:79]
    s_waitcnt lgkmcnt(0)
    v_mfma_f32_32x32x16_bf16 v[64:79], v[172:175], v[204:207], v[64:79]
    s_barrier
    ds_read_b128 v[224:227], v6 offset:49152
    ds_read_b128 v[228:231], v6 offset:49408
    ds_read_b128 v[232:235], v6 offset:53248
    ds_read_b128 v[236:239], v6 offset:53504
    ds_read_b128 v[240:243], v6 offset:57344
    ds_read_b128 v[244:247], v6 offset:57600
    ds_read_b128 v[248:251], v6 offset:61440
    ds_read_b128 v[252:255], v6 offset:61696
    v_mfma_f32_32x32x16_bf16 v[64:79], v[176:179], v[208:211], v[64:79]
    v_mfma_f32_32x32x16_bf16 v[64:79], v[180:183], v[212:215], v[64:79]
    v_mfma_f32_32x32x16_bf16 v[64:79], v[184:187], v[216:219], v[64:79]
    v_mfma_f32_32x32x16_bf16 v[64:79], v[188:191], v[220:223], v[64:79]
    s_waitcnt lgkmcnt(7)
    v_mfma_f32_32x32x16_bf16 v[64:79], v[32:35], v[224:227], v[64:79]
    v_add_f32 v80, v80, v96
    v_add_f32 v81, v81, v97
    v_add_f32 v82, v82, v98
    v_add_f32 v83, v83, v99
    s_waitcnt lgkmcnt(6)
    v_mfma_f32_32x32x16_bf16 v[64:79], v[36:39], v[228:231], v[64:79]
    v_add_f32 v84, v84, v100
    v_add_f32 v85, v85, v101
    v_add_f32 v86, v86, v102
    v_add_f32 v87, v87, v103
    s_waitcnt lgkmcnt(5)
    v_mfma_f32_32x32x16_bf16 v[64:79], v[40:43], v[232:235], v[64:79]
    v_add_f32 v88, v88, v104
    v_add_f32 v89, v89, v105
    v_add_f32 v90, v90, v106
    v_add_f32 v91, v91, v107
    s_waitcnt lgkmcnt(0)
    v_mfma_f32_32x32x16_bf16 v[64:79], v[44:47], v[236:239], v[64:79]
    v_add_f32 v92, v92, v108
    v_add_f32 v93, v93, v109
    v_add_f32 v94, v94, v110
    v_add_f32 v95, v95, v111
    v_mfma_f32_32x32x16_bf16 v[64:79], v[48:51], v[240:243], v[64:79]
    s_waitcnt vmcnt(0)
    v_sub_f32 v25, 1.0, v24
    v_mul_f32 v80, v80, v24
    v_mul_f32 v81, v81, v24
    v_mul_f32 v82, v82, v24
    v_mul_f32 v83, v83, v24
    v_mfma_f32_32x32x16_bf16 v[64:79], v[52:55], v[244:247], v[64:79]
    v_mul_f32 v84, v84, v24
    v_mul_f32 v85, v85, v24
    v_mul_f32 v86, v86, v24
    v_mul_f32 v87, v87, v24
    v_mfma_f32_32x32x16_bf16 v[64:79], v[56:59], v[248:251], v[64:79]
    v_mul_f32 v88, v88, v24
    v_mul_f32 v89, v89, v24
    v_mul_f32 v90, v90, v24
    v_mul_f32 v91, v91, v24
    v_mfma_f32_32x32x16_bf16 v[64:79], v[60:63], v[252:255], v[64:79]
    v_mul_f32 v92, v92, v24
    v_mul_f32 v93, v93, v24
    v_mul_f32 v94, v94, v24
    v_mul_f32 v95, v95, v24
    s_nop 7
    v_fmac_f32 v80, v64, v25
    v_fmac_f32 v81, v65, v25
    v_fmac_f32 v82, v66, v25
    v_fmac_f32 v83, v67, v25
    v_fmac_f32 v84, v68, v25
    v_fmac_f32 v85, v69, v25
    v_fmac_f32 v86, v70, v25
    v_fmac_f32 v87, v71, v25
    v_fmac_f32 v88, v72, v25
    v_fmac_f32 v89, v73, v25
    v_fmac_f32 v90, v74, v25
    v_fmac_f32 v91, v75, v25
    v_fmac_f32 v92, v76, v25
    v_fmac_f32 v93, v77, v25
    v_fmac_f32 v94, v78, v25
    v_fmac_f32 v95, v79, v25
    v_cvt_pk_bf16_f32 v192, v80, v81
    v_cvt_pk_bf16_f32 v193, v82, v83
    v_cvt_pk_bf16_f32 v194, v84, v85
    v_cvt_pk_bf16_f32 v195, v86, v87
    v_cvt_pk_bf16_f32 v196, v88, v89
    v_cvt_pk_bf16_f32 v197, v90, v91
    v_cvt_pk_bf16_f32 v198, v92, v93
    v_cvt_pk_bf16_f32 v199, v94, v95
    buffer_store_dwordx4 v[192:195], v28, s[68:71], s14 offen
    buffer_store_dwordx4 v[196:199], v28, s[68:71], s14 offen offset:16
    s_endpgm
att_fb:
    s_cmp_lg_u32 s15, 0
    s_cbranch_scc1 att_fin
    s_mov_b32 s15, 1
    s_mov_b32 s75, 0
    s_mov_b32 s14, 0xff800000
    v_mov_b32 v3, s14
    ds_read_b128 v[144:147], v8 offset:32768
    s_waitcnt lgkmcnt(0)
    v_mfma_f32_32x32x16_bf16 v[64:79], v[144:147], v[20:23], 0
    s_nop 11
    v_bfi_b32 v64, v192, s14, v64
    v_bfi_b32 v65, v193, s14, v65
    v_bfi_b32 v66, v194, s14, v66
    v_bfi_b32 v67, v195, s14, v67
    v_bfi_b32 v68, v196, s14, v68
    v_bfi_b32 v69, v197, s14, v69
    v_bfi_b32 v70, v198, s14, v70
    v_bfi_b32 v71, v199, s14, v71
    v_bfi_b32 v72, v200, s14, v72
    v_bfi_b32 v73, v201, s14, v73
    v_bfi_b32 v74, v202, s14, v74
    v_bfi_b32 v75, v203, s14, v75
    v_bfi_b32 v76, v204, s14, v76
    v_bfi_b32 v77, v205, s14, v77
    v_bfi_b32 v78, v206, s14, v78
    v_bfi_b32 v79, v207, s14, v79
    v_max3_f32 v3, v3, v64, v65
    v_max3_f32 v3, v3, v66, v67
    v_max3_f32 v3, v3, v68, v69
    v_max3_f32 v3, v3, v70, v71
    v_max3_f32 v3, v3, v72, v73
    v_max3_f32 v3, v3, v74, v75
    v_max3_f32 v3, v3, v76, v77
    v_max3_f32 v3, v3, v78, v79
    s_cmp_eq_u32 s61, 1
    s_cbranch_scc1 att_fb2
    ds_read_b128 v[144:147], v8 offset:28672
    s_waitcnt lgkmcnt(0)
    v_mfma_f32_32x32x16_bf16 v[64:79], v[144:147], v[20:23], 0
    s_nop 11
    v_max3_f32 v3, v3, v64, v65
    v_max3_f32 v3, v3, v66, v67
    v_max3_f32 v3, v3, v68, v69
    v_max3_f32 v3, v3, v70, v71
    v_max3_f32 v3, v3, v72, v73
    v_max3_f32 v3, v3, v74, v75
    v_max3_f32 v3, v3, v76, v77
    v_max3_f32 v3, v3, v78, v79
    s_cmp_eq_u32 s61, 2
    s_cbranch_scc1 att_fb2
    ds_read_b128 v[144:147], v8 offset:24576
    s_waitcnt lgkmcnt(0)
    v_mfma_f32_32x32x16_bf16 v[64:79], v[144:147], v[20:23], 0
    s_nop 11
    v_max3_f32 v3, v3, v64, v65
    v_max3_f32 v3, v3, v66, v67
    v_max3_f32 v3, v3, v68, v69
    v_max3_f32 v3, v3, v70, v71
    v_max3_f32 v3, v3, v72, v73
    v_max3_f32 v3, v3, v74, v75
    v_max3_f32 v3, v3, v76, v77
    v_max3_f32 v3, v3, v78, v79
    s_cmp_eq_u32 s61, 3
    s_cbranch_scc1 att_fb2
    ds_read_b128 v[144:147], v8 offset:20480
    s_waitcnt lgkmcnt(0)
    v_mfma_f32_32x32x16_bf16 v[64:79], v[144:147], v[20:23], 0
    s_nop 11
    v_max3_f32 v3, v3, v64, v65
    v_max3_f32 v3, v3, v66, v67
    v_max3_f32 v3, v3, v68, v69
    v_max3_f32 v3, v3, v70, v71
    v_max3_f32 v3, v3, v72, v73
    v_max3_f32 v3, v3, v74, v75
    v_max3_f32 v3, v3, v76, v77
    v_max3_f32 v3, v3, v78, v79
    s_cmp_eq_u32 s61, 4
    s_cbranch_scc1 att_fb2
    ds_read_b128 v[144:147], v8 offset:16384
    s_waitcnt lgkmcnt(0)
    v_mfma_f32_32x32x16_bf16 v[64:79], v[144:147], v[20:23], 0
    s_nop 11
    v_max3_f32 v3, v3, v64, v65
    v_max3_f32 v3, v3, v66, v67
    v_max3_f32 v3, v3, v68, v69
    v_max3_f32 v3, v3, v70, v71
    v_max3_f32 v3, v3, v72, v73
    v_max3_f32 v3, v3, v74, v75
    v_max3_f32 v3, v3, v76, v77
    v_max3_f32 v3, v3, v78, v79
    s_cmp_eq_u32 s61, 5
    s_cbranch_scc1 att_fb2
    ds_read_b128 v[144:147], v8 offset:12288
    s_waitcnt lgkmcnt(0)
    v_mfma_f32_32x32x16_bf16 v[64:79], v[144:147], v[20:23], 0
    s_nop 11
    v_max3_f32 v3, v3, v64, v65
    v_max3_f32 v3, v3, v66, v67
    v_max3_f32 v3, v3, v68, v69
    v_max3_f32 v3, v3, v70, v71
    v_max3_f32 v3, v3, v72, v73
    v_max3_f32 v3, v3, v74, v75
    v_max3_f32 v3, v3, v76, v77
    v_max3_f32 v3, v3, v78, v79
    s_cmp_eq_u32 s61, 6
    s_cbranch_scc1 att_fb2
    ds_read_b128 v[144:147], v8 offset:8192
    s_waitcnt lgkmcnt(0)
    v_mfma_f32_32x32x16_bf16 v[64:79], v[144:147], v[20:23], 0
    s_nop 11
    v_max3_f32 v3, v3, v64, v65
    v_max3_f32 v3, v3, v66, v67
    v_max3_f32 v3, v3, v68, v69
    v_max3_f32 v3, v3, v70, v71
    v_max3_f32 v3, v3, v72, v73
    v_max3_f32 v3, v3, v74, v75
    v_max3_f32 v3, v3, v76, v77
    v_max3_f32 v3, v3, v78, v79
    s_cmp_eq_u32 s61, 7
    s_cbranch_scc1 att_fb2
    ds_read_b128 v[144:147], v8 offset:4096
    s_waitcnt lgkmcnt(0)
    v_mfma_f32_32x32x16_bf16 v[64:79], v[144:147], v[20:23], 0
    s_nop 11
    v_max3_f32 v3, v3, v64, v65
    v_max3_f32 v3, v3, v66, v67
    v_max3_f32 v3, v3, v68, v69
    v_max3_f32 v3, v3, v70, v71
    v_max3_f32 v3, v3, v72, v73
    v_max3_f32 v3, v3, v74, v75
    v_max3_f32 v3, v3, v76, v77
    v_max3_f32 v3, v3, v78, v79
    s_cmp_eq_u32 s61, 8
    s_cbranch_scc1 att_fb2
    ds_read_b128 v[144:147], v8 offset:0
    s_waitcnt lgkmcnt(0)
    v_mfma_f32_32x32x16_bf16 v[64:79], v[144:147], v[20:23], 0
    s_nop 11
    v_bfi_b32 v64, v192, v64, s14
    v_bfi_b32 v65, v193, v65, s14
    v_bfi_b32 v66, v194, v66, s14
    v_bfi_b32 v67, v195, v67, s14
    v_bfi_b32 v68, v196, v68, s14
    v_bfi_b32 v69, v197, v69, s14
    v_bfi_b32 v70, v198, v70, s14
    v_bfi_b32 v71, v199, v71, s14
    v_bfi_b32 v72, v200, v72, s14
    v_bfi_b32 v73, v201, v73, s14
    v_bfi_b32 v74, v202, v74, s14
    v_bfi_b32 v75, v203, v75, s14
    v_bfi_b32 v76, v204, v76, s14
    v_bfi_b32 v77, v205, v77, s14
    v_bfi_b32 v78, v206, v78, s14
    v_bfi_b32 v79, v207, v79, s14
    v_max3_f32 v3, v3, v64, v65
    v_max3_f32 v3, v3, v66, v67
    v_max3_f32 v3, v3, v68, v69
    v_max3_f32 v3, v3, v70, v71
    v_max3_f32 v3, v3, v72, v73
    v_max3_f32 v3, v3, v74, v75
    v_max3_f32 v3, v3, v76, v77
    v_max3_f32 v3, v3, v78, v79
att_fb2:
    v_mov_b32 v4, v3
    s_nop 1
    v_permlane32_swap_b32 v4, v3
    s_nop 0
    v_max_f32 v3, v4, v3
    v_sub_f32 v112, 0, v3
    v_sub_f32 v113, 0, v3
    v_mov_b64 v[114:115], v[112:113]
    v_mov_b64 v[116:117], v[112:113]
    v_mov_b64 v[118:119], v[112:113]
    v_mov_b64 v[120:121], v[112:113]
    v_mov_b64 v[122:123], v[112:113]
    v_mov_b64 v[124:125], v[112:113]
    v_mov_b64 v[126:127], v[112:113]
    s_branch att_retry
.p2align 6
gated_mix__spectral_fnet__sliding_block__prompt_kernel_L:
    s_mov_b32 s48, s38
    s_mov_b32 s49, s39
    s_mov_b32 s50, 16777216
    s_mov_b32 s51, 0x00020000
    s_mov_b32 s56, s36
    s_mov_b32 s57, s37
    s_mov_b32 s58, 256
    s_mov_b32 s59, 0x00020000
    s_xor_b32 s9, s60, 3
    s_or_b32 s9, s9, s2
    s_cmp_lg_u32 s9, 0
    s_cbranch_scc1 gated_mix__spectral_fnet__sliding_block__prompt_kernel_nn
    v_lshlrev_b32 v4, 8, v0
    v_mov_b32 v5, 0
    s_mov_b32 s9, 11534336
    buffer_store_dword v5, v4, s[48:51], s9 offen sc1
    s_memrealtime s[10:11]
    s_waitcnt vmcnt(0) lgkmcnt(0)
    s_or_b32 s10, s10, 1
    v_mov_b32 v4, s10
    s_mov_b64 exec, 1
    buffer_store_dword v4, off, s[56:59], 0 sc1
    s_mov_b64 exec, -1
gated_mix__spectral_fnet__sliding_block__prompt_kernel_nn:
    v_lshrrev_b32 v5, 2, v0
    v_mul_u32_u24 v5, 3072, v5
    v_lshl_add_u32 v5, v7, 4, v5
    s_lshl_b32 s10, s7, 6
    s_add_u32 s10, s10, s8
    v_add_u32 v102, s10, v5
    v_and_b32 v1, 31, v0
    v_lshrrev_b32 v2, 5, v0
    v_xor_b32 v5, v1, v2
    v_lshlrev_b32 v5, 4, v5
    v_lshl_add_u32 v5, v2, 17, v5
    s_lshl_b32 s10, s64, 2
    s_add_u32 s10, s10, s60
    s_lshl_b32 s10, s10, 10
    v_add_u32 v5, s10, v5
    v_xor_b32 v104, 0, v5
    v_xor_b32 v105, 32, v5
    v_add_u32 v105, 261120, v105
    v_xor_b32 v106, 64, v5
    v_add_u32 v106, 522240, v106
    v_xor_b32 v107, 96, v5
    v_add_u32 v107, 783360, v107
    v_xor_b32 v108, 128, v5
    v_add_u32 v108, 1048576, v108
    v_xor_b32 v109, 160, v5
    v_add_u32 v109, 1309696, v109
    v_xor_b32 v110, 192, v5
    v_add_u32 v110, 1570816, v110
    v_xor_b32 v111, 224, v5
    v_add_u32 v111, 1831936, v111
    v_and_b32 v5, 15, v0
    v_xor_b32 v5, v5, v2
    v_lshlrev_b32 v5, 4, v5
    v_lshl_add_u32 v5, v1, 9, v5
    s_lshr_b32 s10, s60, 1
    s_lshl_b32 s10, s10, 14
    s_add_u32 s10, s10, 131072
    v_add_u32 v112, s10, v5
    v_xor_b32 v113, 32, v112
    v_xor_b32 v114, 64, v112
    v_xor_b32 v115, 96, v112
    v_xor_b32 v116, 128, v112
    v_xor_b32 v117, 160, v112
    v_xor_b32 v118, 192, v112
    v_xor_b32 v119, 224, v112
    v_mov_b32 v124, 98048
    v_mov_b32 v125, 1
    s_lshl_b32 s10, s65, 5
    v_add_u32 v5, s10, v1
    s_and_b32 s11, s60, 1
    v_lshlrev_b32 v15, 31, v5
    v_or_b32 v15, 1.0, v15
    v_sub_u32 v6, v5, s11
    v_ashrrev_i32 v6, 31, v6
    v_and_b32 v7, 256, v6
    v_or_b32 v5, v5, v7
    v_cvt_f32_u32 v120, v5
    v_mul_f32 v120, 0x3b000000, v120
    s_mul_i32 s11, s11, 0x3e800000
    v_not_b32 v6, v6
    v_and_b32 v121, s11, v6
    v_cvt_f32_u32 v5, v2
    v_mul_f32 v5, 0x41000000, v5
    v_fmac_f32 v121, v5, v120
    v_mul_f32 v123, 0x41800000, v120
    v_cos_f32 v123, v123
    s_nop 0
    v_add_f32 v123, v123, v123
    s_barrier
    s_cmp_lg_u32 s60, 0
    s_cbranch_scc1 gated_mix__spectral_fnet__sliding_block__prompt_kernel_w1
    s_and_b32 s9, s4, 3
    s_lshl_b32 s9, s9, 1
    s_add_u32 s9, s9, s6
    s_mul_i32 s9, s9, 196608
    s_lshl_b32 s10, s5, 7
    s_add_u32 s9, s9, s10
    v_mul_u32_u24 v4, 3072, v0
    buffer_load_dword v127, v4, s[44:47], s9 offen
gated_mix__spectral_fnet__sliding_block__prompt_kernel_w1:
    s_xor_b32 s9, s66, 2
    s_add_u32 m0, s14, 65536
    s_lshl_b32 s10, s9, 7
    s_mul_i32 s11, s9, 196608
    buffer_load_dwordx4 v96, s[40:43], s10 offen offset:0 lds
    v_fmamk_f32 v16, v120, 0x00000000, v121
    v_add_f32 v17, v16, v120
    v_cos_f32 v16, v16
    v_cos_f32 v17, v17
    s_nop 0
    v_cvt_pk_bf16_f32 v128, v16, v17
    buffer_load_dwordx4 v97, s[40:43], s10 offen offset:1024 lds
    v_fmamk_f32 v18, v120, 0x40000000, v121
    v_add_f32 v19, v18, v120
    v_cos_f32 v18, v18
    v_cos_f32 v19, v19
    s_nop 0
    v_cvt_pk_bf16_f32 v129, v18, v19
    buffer_load_dwordx4 v98, s[40:43], s10 offen offset:2048 lds
    v_fmamk_f32 v20, v120, 0x40800000, v121
    v_add_f32 v21, v20, v120
    v_cos_f32 v20, v20
    v_cos_f32 v21, v21
    s_nop 0
    v_cvt_pk_bf16_f32 v130, v20, v21
    buffer_load_dwordx4 v99, s[40:43], s10 offen offset:3072 lds
    v_fmamk_f32 v22, v120, 0x40c00000, v121
    v_add_f32 v23, v22, v120
    v_cos_f32 v22, v22
    v_cos_f32 v23, v23
    s_nop 0
    v_cvt_pk_bf16_f32 v131, v22, v23
    s_add_u32 m0, s67, 81920
    s_nop 0
    buffer_load_dwordx4 v100, s[44:47], s11 offen offset:0 lds
    v_fmamk_f32 v24, v120, 0x41800000, v121
    v_add_f32 v25, v24, v120
    v_cos_f32 v24, v24
    v_cos_f32 v25, v25
    s_nop 0
    v_cvt_pk_bf16_f32 v132, v24, v25
    buffer_load_dwordx4 v101, s[44:47], s11 offen offset:1024 lds
    v_fmamk_f32 v26, v120, 0x41900000, v121
    v_add_f32 v27, v26, v120
    v_cos_f32 v26, v26
    v_cos_f32 v27, v27
    s_nop 0
    v_cvt_pk_bf16_f32 v133, v26, v27
    s_cmp_lg_u32 s60, 3
    s_cbranch_scc1 gated_mix__spectral_fnet__sliding_block__prompt_kernel_ntt
    s_mov_b32 s68, s34
    s_mov_b32 s69, s35
    s_mov_b32 s70, 2097152
    s_mov_b32 s71, 0x00020000
    s_mov_b32 s52, s30
    s_mov_b32 s53, s31
    s_mov_b32 s54, 524288
    s_mov_b32 s55, 0x00020000
    v_lshlrev_b32 v4, 21, v0
    v_add_u32 v4, 0x1fff80, v4
    s_mov_b64 exec, 63
    buffer_load_dword v127, v4, s[48:51], 0 offen sc1
    s_mov_b64 exec, 1
    buffer_load_dword v127, off, s[68:71], 0 sc1
    buffer_load_dword v127, off, s[52:55], 0
    buffer_load_dword v127, off, s[56:59], 0 offset:128 sc1
    s_mov_b64 exec, -1
gated_mix__spectral_fnet__sliding_block__prompt_kernel_ntt:
    s_mov_b32 s52, s32
    s_mov_b32 s53, s33
    s_mov_b32 s54, 1024
    s_mov_b32 s55, 0x00020000
    v_lshlrev_b32 v6, 5, v0
    v_and_b32 v6, 1023, v6
    buffer_load_dwordx4 v[56:59], v6, s[52:55], 0 offen
    buffer_load_dwordx4 v[60:63], v6, s[52:55], 0 offen offset:16
    v_and_b32 v2, 31, v0
    v_lshrrev_b32 v3, 5, v0
    v_lshlrev_b32 v4, v2, -2
    v_lshlrev_b32 v5, 2, v3
    v_lshrrev_b32 v4, v5, v4
    s_mov_b32 s13, 0xffff
    v_bfe_i32 v192, v4, 0, 1
    v_bfe_i32 v193, v4, 1, 1
    v_bfe_i32 v194, v4, 2, 1
    v_bfe_i32 v195, v4, 3, 1
    v_bfe_i32 v196, v4, 8, 1
    v_bfe_i32 v197, v4, 9, 1
    v_bfe_i32 v198, v4, 10, 1
    v_bfe_i32 v199, v4, 11, 1
    v_bfe_i32 v200, v4, 16, 1
    v_bfe_i32 v201, v4, 17, 1
    v_bfe_i32 v202, v4, 18, 1
    v_bfe_i32 v203, v4, 19, 1
    v_bfe_i32 v204, v4, 24, 1
    v_bfe_i32 v205, v4, 25, 1
    v_bfe_i32 v206, v4, 26, 1
    v_bfe_i32 v207, v4, 27, 1
    v_bfi_b32 v208, s13, v192, v193
    v_bfi_b32 v209, s13, v194, v195
    v_bfi_b32 v210, s13, v196, v197
    v_bfi_b32 v211, s13, v198, v199
    v_bfi_b32 v212, s13, v200, v201
    v_bfi_b32 v213, s13, v202, v203
    v_bfi_b32 v214, s13, v204, v205
    v_bfi_b32 v215, s13, v206, v207
    v_mov_b32 v216, 0x3f803f80
    v_mov_b32 v217, v216
    v_mov_b64 v[218:219], v[216:217]
    v_mov_b64 v[220:221], v[216:217]
    v_mov_b64 v[222:223], v[216:217]
    v_mov_b64 v[224:225], v[216:217]
    v_mov_b64 v[226:227], v[216:217]
    v_mov_b64 v[228:229], v[216:217]
    v_mov_b64 v[230:231], v[216:217]
    v_mov_b64 v[232:233], v[216:217]
    v_mov_b64 v[234:235], v[216:217]
    v_mov_b64 v[236:237], v[216:217]
    v_mov_b64 v[238:239], v[216:217]
    v_mov_b64 v[240:241], v[216:217]
    v_mov_b64 v[242:243], v[216:217]
    v_mov_b64 v[244:245], v[216:217]
    v_mov_b64 v[246:247], v[216:217]
    s_and_b32 s9, s3, 3
    s_lshr_b32 s10, s3, 2
    s_lshl_b32 s11, s9, 12
    s_add_u32 s11, s11, 32768
    s_lshl_b32 s12, s10, 10
    s_add_u32 s12, s12, s11
    v_lshlrev_b32 v4, 4, v0
    v_add_u32 v8, s12, v4
    s_lshl_b32 s12, s10, 8
    s_add_u32 s12, s12, s11
    v_add_u32 v9, s12, v4
    v_and_b32 v5, 15, v0
    v_mul_u32_u24 v5, 528, v5
    s_and_b32 s12, s4, 1
    v_xor_b32 v6, s12, v3
    v_lshl_add_u32 v5, v6, 7, v5
    v_bfe_u32 v6, v0, 4, 1
    v_lshl_add_u32 v5, v6, 4, v5
    s_lshl_b32 s12, s10, 8
    s_lshl_b32 s11, s9, 5
    s_add_u32 s12, s12, s11
    s_add_u32 s12, s12, 16384
    v_add_u32 v10, s12, v5
    s_mul_i32 s12, s3, 1056
    s_add_u32 s12, s12, 16384
    v_mul_u32_u24 v5, 528, v3
    v_lshl_add_u32 v5, v2, 4, v5
    v_add_u32 v11, s12, v5
    v_mul_u32_u24 v5, 132096, v3
    v_lshl_add_u32 v12, v2, 4, v5
    s_lshl_b32 s61, s4, 2
    s_add_u32 s61, s61, s9
    s_add_u32 s61, s61, 1
    s_min_u32 s61, s61, 9
    s_mul_i32 s62, s3, 264192
    s_lshr_b32 s11, s4, 3
    s_lshl_b32 s11, s11, 16
    s_add_u32 s62, s62, s11
    s_lshl_b32 s11, s7, 12
    s_add_u32 s62, s62, s11
    s_and_b32 s11, s4, 7
    s_lshl_b32 s11, s11, 9
    s_add_u32 s62, s62, s11
    s_add_u32 s62, s62, 7340032
    s_and_b32 s72, s2, 7
    s_lshl_b32 s72, s72, 1
    s_bfe_u32 s11, s2, 0x10003
    s_add_u32 s72, s72, s11
    s_bfe_u32 s73, s2, 0x10004
    s_lshr_b32 s74, s2, 5
    s_mov_b32 s75, 0
    v_lshlrev_b32 v14, 4, v0
    v_lshrrev_b32 v4, 3, v0
    v_lshlrev_b32 v4, 10, v4
    v_bfe_u32 v5, v0, 2, 1
    v_bfe_u32 v6, v0, 4, 1
    v_xor_b32 v5, v5, v6
    v_lshl_add_u32 v4, v5, 6, v4
    v_and_b32 v5, 3, v0
    v_lshl_add_u32 v4, v5, 4, v4
    s_lshl_b32 s11, s3, 16
    s_lshl_b32 s12, s74, 7
    s_add_u32 s11, s11, s12
    v_add_u32 v13, s11, v4
    s_mov_b32 s68, s30
    s_mov_b32 s69, s31
    s_mov_b32 s70, 524288
    s_mov_b32 s71, 0x00020000
    s_xor_b32 s9, s66, 3
    s_add_u32 m0, s14, 98304
    s_lshl_b32 s10, s9, 7
    s_mul_i32 s11, s9, 196608
    buffer_load_dwordx4 v96, s[40:43], s10 offen offset:0 lds
    v_fmamk_f32 v28, v120, 0x41a00000, v121
    v_add_f32 v29, v28, v120
    v_cos_f32 v28, v28
    v_cos_f32 v29, v29
    s_nop 0
    v_cvt_pk_bf16_f32 v134, v28, v29
    buffer_load_dwordx4 v97, s[40:43], s10 offen offset:1024 lds
    v_fmamk_f32 v30, v120, 0x41b00000, v121
    v_add_f32 v31, v30, v120
    v_cos_f32 v30, v30
    v_cos_f32 v31, v31
    s_nop 0
    v_cvt_pk_bf16_f32 v135, v30, v31
    buffer_load_dwordx4 v98, s[40:43], s10 offen offset:2048 lds
    v_fma_f32 v16, v123, v24, -v16
    v_fma_f32 v17, v123, v25, -v17
    v_cvt_pk_bf16_f32 v136, v16, v17
    buffer_load_dwordx4 v99, s[40:43], s10 offen offset:3072 lds
    v_fma_f32 v18, v123, v26, -v18
    v_fma_f32 v19, v123, v27, -v19
    v_cvt_pk_bf16_f32 v137, v18, v19
    s_add_u32 m0, s67, 114688
    s_nop 0
    buffer_load_dwordx4 v100, s[44:47], s11 offen offset:0 lds
    v_fma_f32 v20, v123, v28, -v20
    v_fma_f32 v21, v123, v29, -v21
    v_cvt_pk_bf16_f32 v138, v20, v21
    buffer_load_dwordx4 v101, s[44:47], s11 offen offset:1024 lds
    v_fma_f32 v22, v123, v30, -v22
    v_fma_f32 v23, v123, v31, -v23
    v_cvt_pk_bf16_f32 v139, v22, v23
    s_xor_b32 s9, s66, 4
    s_add_u32 m0, s14, 131072
    s_lshl_b32 s10, s9, 7
    s_mul_i32 s11, s9, 196608
    buffer_load_dwordx4 v96, s[40:43], s10 offen offset:0 lds
    v_fma_f32 v24, v123, v16, -v24
    v_fma_f32 v25, v123, v17, -v25
    v_cvt_pk_bf16_f32 v140, v24, v25
    buffer_load_dwordx4 v97, s[40:43], s10 offen offset:1024 lds
    v_fma_f32 v26, v123, v18, -v26
    v_fma_f32 v27, v123, v19, -v27
    v_cvt_pk_bf16_f32 v141, v26, v27
    buffer_load_dwordx4 v98, s[40:43], s10 offen offset:2048 lds
    v_fma_f32 v28, v123, v20, -v28
    v_fma_f32 v29, v123, v21, -v29
    v_cvt_pk_bf16_f32 v142, v28, v29
    buffer_load_dwordx4 v99, s[40:43], s10 offen offset:3072 lds
    v_fma_f32 v30, v123, v22, -v30
    v_fma_f32 v31, v123, v23, -v31
    v_cvt_pk_bf16_f32 v143, v30, v31
    s_add_u32 m0, s67, 147456
    s_nop 0
    buffer_load_dwordx4 v100, s[44:47], s11 offen offset:0 lds
    v_fma_f32 v16, v123, v24, -v16
    v_fma_f32 v17, v123, v25, -v17
    v_cvt_pk_bf16_f32 v144, v16, v17
    buffer_load_dwordx4 v101, s[44:47], s11 offen offset:1024 lds
    v_fma_f32 v18, v123, v26, -v18
    v_fma_f32 v19, v123, v27, -v19
    v_cvt_pk_bf16_f32 v145, v18, v19
    s_waitcnt vmcnt(12)
    s_barrier
    s_xor_b32 s9, s66, 5
    s_add_u32 m0, s14, 0
    s_lshl_b32 s10, s9, 7
    s_mul_i32 s11, s9, 196608
    buffer_load_dwordx4 v96, s[40:43], s10 offen offset:0 lds
    v_fma_f32 v20, v123, v28, -v20
    v_fma_f32 v21, v123, v29, -v21
    v_cvt_pk_bf16_f32 v146, v20, v21
    buffer_load_dwordx4 v97, s[40:43], s10 offen offset:1024 lds
    v_fma_f32 v22, v123, v30, -v22
    v_fma_f32 v23, v123, v31, -v23
    v_cvt_pk_bf16_f32 v147, v22, v23
    buffer_load_dwordx4 v98, s[40:43], s10 offen offset:2048 lds
    v_fma_f32 v24, v123, v16, -v24
    v_fma_f32 v25, v123, v17, -v25
    v_cvt_pk_bf16_f32 v148, v24, v25
    buffer_load_dwordx4 v99, s[40:43], s10 offen offset:3072 lds
    v_fma_f32 v26, v123, v18, -v26
    v_fma_f32 v27, v123, v19, -v27
    v_cvt_pk_bf16_f32 v149, v26, v27
    s_add_u32 m0, s67, 16384
    s_nop 0
    buffer_load_dwordx4 v100, s[44:47], s11 offen offset:0 lds
    v_fma_f32 v28, v123, v20, -v28
    v_fma_f32 v29, v123, v21, -v29
    v_cvt_pk_bf16_f32 v150, v28, v29
    buffer_load_dwordx4 v101, s[44:47], s11 offen offset:1024 lds
    v_fma_f32 v30, v123, v22, -v30
    v_fma_f32 v31, v123, v23, -v31
    v_cvt_pk_bf16_f32 v151, v30, v31
    s_waitcnt vmcnt(12)
    s_barrier
    s_xor_b32 s9, s66, 6
    s_add_u32 m0, s14, 32768
    s_lshl_b32 s10, s9, 7
    s_mul_i32 s11, s9, 196608
    buffer_load_dwordx4 v96, s[40:43], s10 offen offset:0 lds
    v_fma_f32 v16, v123, v24, -v16
    v_fma_f32 v17, v123, v25, -v17
    v_cvt_pk_bf16_f32 v152, v16, v17
    buffer_load_dwordx4 v97, s[40:43], s10 offen offset:1024 lds
    v_fma_f32 v18, v123, v26, -v18
    v_fma_f32 v19, v123, v27, -v19
    v_cvt_pk_bf16_f32 v153, v18, v19
    buffer_load_dwordx4 v98, s[40:43], s10 offen offset:2048 lds
    v_fma_f32 v20, v123, v28, -v20
    v_fma_f32 v21, v123, v29, -v21
    v_cvt_pk_bf16_f32 v154, v20, v21
    buffer_load_dwordx4 v99, s[40:43], s10 offen offset:3072 lds
    v_fma_f32 v22, v123, v30, -v22
    v_fma_f32 v23, v123, v31, -v23
    v_cvt_pk_bf16_f32 v155, v22, v23
    s_add_u32 m0, s67, 49152
    s_nop 0
    buffer_load_dwordx4 v100, s[44:47], s11 offen offset:0 lds
    v_fma_f32 v24, v123, v16, -v24
    v_fma_f32 v25, v123, v17, -v25
    v_cvt_pk_bf16_f32 v156, v24, v25
    buffer_load_dwordx4 v101, s[44:47], s11 offen offset:1024 lds
    v_fma_f32 v26, v123, v18, -v26
    v_fma_f32 v27, v123, v19, -v27
    v_cvt_pk_bf16_f32 v157, v26, v27
    s_waitcnt vmcnt(12)
    s_barrier
    s_xor_b32 s9, s66, 7
    s_add_u32 m0, s14, 65536
    s_lshl_b32 s10, s9, 7
    s_mul_i32 s11, s9, 196608
    buffer_load_dwordx4 v96, s[40:43], s10 offen offset:0 lds
    v_fma_f32 v28, v123, v20, -v28
    v_fma_f32 v29, v123, v21, -v29
    v_cvt_pk_bf16_f32 v158, v28, v29
    buffer_load_dwordx4 v97, s[40:43], s10 offen offset:1024 lds
    v_fma_f32 v30, v123, v22, -v30
    v_fma_f32 v31, v123, v23, -v31
    v_cvt_pk_bf16_f32 v159, v30, v31
    buffer_load_dwordx4 v98, s[40:43], s10 offen offset:2048 lds
    v_fma_f32 v16, v123, v24, -v16
    v_fma_f32 v17, v123, v25, -v17
    v_cvt_pk_bf16_f32 v160, v16, v17
    buffer_load_dwordx4 v99, s[40:43], s10 offen offset:3072 lds
    v_fma_f32 v18, v123, v26, -v18
    v_fma_f32 v19, v123, v27, -v19
    v_cvt_pk_bf16_f32 v161, v18, v19
    s_add_u32 m0, s67, 81920
    s_nop 0
    buffer_load_dwordx4 v100, s[44:47], s11 offen offset:0 lds
    v_fma_f32 v20, v123, v28, -v20
    v_fma_f32 v21, v123, v29, -v21
    v_cvt_pk_bf16_f32 v162, v20, v21
    buffer_load_dwordx4 v101, s[44:47], s11 offen offset:1024 lds
    v_fma_f32 v22, v123, v30, -v22
    v_fma_f32 v23, v123, v31, -v23
    v_cvt_pk_bf16_f32 v163, v22, v23
    s_waitcnt vmcnt(12)
    s_barrier
    s_waitcnt vmcnt(0)
    s_barrier
    s_lshr_b32 s12, s67, 1
    s_xor_b32 s9, s66, 0
    s_add_u32 m0, s12, 98304
    s_mul_i32 s11, s9, 196608
    buffer_load_dwordx4 v102, s[44:47], s11 offen lds
    v_fma_f32 v24, v123, v16, -v24
    v_fma_f32 v25, v123, v17, -v25
    v_cvt_pk_bf16_f32 v164, v24, v25
    s_xor_b32 s9, s66, 1
    s_add_u32 m0, s12, 102400
    s_mul_i32 s11, s9, 196608
    buffer_load_dwordx4 v102, s[44:47], s11 offen lds
    v_fma_f32 v26, v123, v18, -v26
    v_fma_f32 v27, v123, v19, -v27
    v_cvt_pk_bf16_f32 v165, v26, v27
    s_xor_b32 s9, s66, 2
    s_add_u32 m0, s12, 106496
    s_mul_i32 s11, s9, 196608
    buffer_load_dwordx4 v102, s[44:47], s11 offen lds
    v_fma_f32 v28, v123, v20, -v28
    v_fma_f32 v29, v123, v21, -v29
    v_cvt_pk_bf16_f32 v166, v28, v29
    s_xor_b32 s9, s66, 3
    s_add_u32 m0, s12, 110592
    s_mul_i32 s11, s9, 196608
    buffer_load_dwordx4 v102, s[44:47], s11 offen lds
    v_fma_f32 v30, v123, v22, -v30
    v_fma_f32 v31, v123, v23, -v31
    v_cvt_pk_bf16_f32 v167, v30, v31
    s_xor_b32 s9, s66, 4
    s_add_u32 m0, s12, 114688
    s_mul_i32 s11, s9, 196608
    buffer_load_dwordx4 v102, s[44:47], s11 offen lds
    v_fma_f32 v16, v123, v24, -v16
    v_fma_f32 v17, v123, v25, -v17
    v_cvt_pk_bf16_f32 v168, v16, v17
    s_xor_b32 s9, s66, 5
    s_add_u32 m0, s12, 118784
    s_mul_i32 s11, s9, 196608
    buffer_load_dwordx4 v102, s[44:47], s11 offen lds
    v_fma_f32 v18, v123, v26, -v18
    v_fma_f32 v19, v123, v27, -v19
    v_cvt_pk_bf16_f32 v169, v18, v19
    s_xor_b32 s9, s66, 6
    s_add_u32 m0, s12, 122880
    s_mul_i32 s11, s9, 196608
    buffer_load_dwordx4 v102, s[44:47], s11 offen lds
    v_fma_f32 v20, v123, v28, -v20
    v_fma_f32 v21, v123, v29, -v21
    v_cvt_pk_bf16_f32 v170, v20, v21
    s_xor_b32 s9, s66, 7
    s_add_u32 m0, s12, 126976
    s_mul_i32 s11, s9, 196608
    buffer_load_dwordx4 v102, s[44:47], s11 offen lds
    v_fma_f32 v22, v123, v30, -v22
    v_fma_f32 v23, v123, v31, -v23
    v_cvt_pk_bf16_f32 v171, v22, v23
    s_lshl_b32 s12, s14, 1
    s_movk_i32 s10, 0
    s_add_u32 m0, s12, 131072
    s_nop 0
    buffer_load_dwordx4 v104, s[40:43], s10 offen offset:0 lds
    v_fma_f32 v24, v123, v16, -v24
    v_fma_f32 v25, v123, v17, -v25
    v_cvt_pk_bf16_f32 v172, v24, v25
    buffer_load_dwordx4 v105, s[40:43], s10 offen offset:1024 lds
    v_fma_f32 v26, v123, v18, -v26
    v_fma_f32 v27, v123, v19, -v27
    v_cvt_pk_bf16_f32 v173, v26, v27
    buffer_load_dwordx4 v106, s[40:43], s10 offen offset:2048 lds
    v_fma_f32 v28, v123, v20, -v28
    v_fma_f32 v29, v123, v21, -v29
    v_cvt_pk_bf16_f32 v174, v28, v29
    buffer_load_dwordx4 v107, s[40:43], s10 offen offset:3072 lds
    v_fma_f32 v30, v123, v22, -v30
    v_fma_f32 v31, v123, v23, -v31
    v_cvt_pk_bf16_f32 v175, v30, v31
    s_add_u32 m0, s12, 135168
    s_nop 0
    buffer_load_dwordx4 v108, s[40:43], s10 offen offset:0 lds
    v_fma_f32 v16, v123, v24, -v16
    v_fma_f32 v17, v123, v25, -v17
    v_cvt_pk_bf16_f32 v176, v16, v17
    buffer_load_dwordx4 v109, s[40:43], s10 offen offset:1024 lds
    v_fma_f32 v18, v123, v26, -v18
    v_fma_f32 v19, v123, v27, -v19
    v_cvt_pk_bf16_f32 v177, v18, v19
    buffer_load_dwordx4 v110, s[40:43], s10 offen offset:2048 lds
    v_fma_f32 v20, v123, v28, -v20
    v_fma_f32 v21, v123, v29, -v21
    v_cvt_pk_bf16_f32 v178, v20, v21
    buffer_load_dwordx4 v111, s[40:43], s10 offen offset:3072 lds
    v_fma_f32 v22, v123, v30, -v22
    v_fma_f32 v23, v123, v31, -v23
    v_cvt_pk_bf16_f32 v179, v22, v23
    s_waitcnt vmcnt(8)
    s_mov_b64 exec, 1
    ds_add_u32 v124, v125 offset:0
    s_mov_b64 exec, -1
lw1:
    ds_read_b32 v126, v124 offset:0
    s_waitcnt lgkmcnt(0)
    v_readfirstlane_b32 s78, v126
    s_cmp_lt_u32 s78, 8
    s_cbranch_scc1 lw1
    s_lshl_b32 s76, s4, 7
    s_lshl_b32 s9, s7, 3
    s_add_u32 s76, s76, s9
    s_lshl_b32 s9, s60, 1
    s_add_u32 s76, s76, s9
    s_lshl_b32 s9, s76, 10
    v_lshlrev_b32 v6, 5, v0
    buffer_load_dwordx4 v[48:51], v6, s[40:43], s9 offen
    buffer_load_dwordx4 v[52:55], v6, s[40:43], s9 offen offset:16
    s_lshl_b32 s12, s14, 1
    s_movk_i32 s10, 512
    s_add_u32 m0, s12, 0
    s_nop 0
    buffer_load_dwordx4 v104, s[40:43], s10 offen offset:0 lds
    v_fma_f32 v24, v123, v16, -v24
    v_fma_f32 v25, v123, v17, -v25
    v_cvt_pk_bf16_f32 v180, v24, v25
    buffer_load_dwordx4 v105, s[40:43], s10 offen offset:1024 lds
    v_fma_f32 v26, v123, v18, -v26
    v_fma_f32 v27, v123, v19, -v27
    v_cvt_pk_bf16_f32 v181, v26, v27
    buffer_load_dwordx4 v106, s[40:43], s10 offen offset:2048 lds
    v_fma_f32 v28, v123, v20, -v28
    v_fma_f32 v29, v123, v21, -v29
    v_cvt_pk_bf16_f32 v182, v28, v29
    buffer_load_dwordx4 v107, s[40:43], s10 offen offset:3072 lds
    v_fma_f32 v30, v123, v22, -v30
    v_fma_f32 v31, v123, v23, -v31
    v_cvt_pk_bf16_f32 v183, v30, v31
    s_add_u32 m0, s12, 4096
    s_nop 0
    buffer_load_dwordx4 v108, s[40:43], s10 offen offset:0 lds
    v_fma_f32 v16, v123, v24, -v16
    v_fma_f32 v17, v123, v25, -v17
    v_cvt_pk_bf16_f32 v184, v16, v17
    buffer_load_dwordx4 v109, s[40:43], s10 offen offset:1024 lds
    v_fma_f32 v18, v123, v26, -v18
    v_fma_f32 v19, v123, v27, -v19
    v_cvt_pk_bf16_f32 v185, v18, v19
    buffer_load_dwordx4 v110, s[40:43], s10 offen offset:2048 lds
    v_fma_f32 v20, v123, v28, -v20
    v_fma_f32 v21, v123, v29, -v21
    v_cvt_pk_bf16_f32 v186, v20, v21
    buffer_load_dwordx4 v111, s[40:43], s10 offen offset:3072 lds
    v_fma_f32 v22, v123, v30, -v22
    v_fma_f32 v23, v123, v31, -v23
    v_cvt_pk_bf16_f32 v187, v22, v23
    v_fma_f32 v24, v123, v16, -v24
    v_fma_f32 v25, v123, v17, -v25
    v_cvt_pk_bf16_f32 v188, v24, v25
    v_fma_f32 v26, v123, v18, -v26
    v_fma_f32 v27, v123, v19, -v27
    v_cvt_pk_bf16_f32 v189, v26, v27
    v_fma_f32 v28, v123, v20, -v28
    v_fma_f32 v29, v123, v21, -v29
    v_cvt_pk_bf16_f32 v190, v28, v29
    v_fma_f32 v30, v123, v22, -v30
    v_fma_f32 v31, v123, v23, -v31
    v_cvt_pk_bf16_f32 v191, v30, v31
    s_waitcnt vmcnt(10)
    s_mov_b64 exec, 1
    ds_add_u32 v124, v125 offset:20
    s_mov_b64 exec, -1
lw2:
    ds_read_b32 v126, v124 offset:20
    s_waitcnt lgkmcnt(0)
    v_readfirstlane_b32 s78, v126
    s_cmp_lt_u32 s78, 4
    s_cbranch_scc1 lw2
    ds_read_b128 v[16:19], v112 offset:0
    ds_read_b128 v[20:23], v113 offset:0
    ds_read_b128 v[24:27], v114 offset:0
    ds_read_b128 v[28:31], v115 offset:0
    ds_read_b128 v[32:35], v116 offset:0
    ds_read_b128 v[36:39], v117 offset:0
    s_waitcnt lgkmcnt(5)
    v_mfma_f32_32x32x16_bf16 v[64:79], v[16:19], v[128:131], 0
    ds_read_b128 v[40:43], v118 offset:0
    s_waitcnt lgkmcnt(5)
    v_mfma_f32_32x32x16_bf16 v[64:79], v[20:23], v[132:135], v[64:79]
    ds_read_b128 v[44:47], v119 offset:0
    s_waitcnt lgkmcnt(5)
    v_mfma_f32_32x32x16_bf16 v[64:79], v[24:27], v[136:139], v[64:79]
    ds_read_b128 v[16:19], v112 offset:256
    v_subrev_u32 v112, 131072, v112
    s_waitcnt lgkmcnt(5)
    v_mfma_f32_32x32x16_bf16 v[64:79], v[28:31], v[140:143], v[64:79]
    ds_read_b128 v[20:23], v113 offset:256
    v_subrev_u32 v113, 131072, v113
    s_waitcnt lgkmcnt(5)
    v_mfma_f32_32x32x16_bf16 v[64:79], v[32:35], v[144:147], v[64:79]
    ds_read_b128 v[24:27], v114 offset:256
    v_subrev_u32 v114, 131072, v114
    s_waitcnt lgkmcnt(5)
    v_mfma_f32_32x32x16_bf16 v[64:79], v[36:39], v[148:151], v[64:79]
    ds_read_b128 v[28:31], v115 offset:256
    v_subrev_u32 v115, 131072, v115
    s_waitcnt lgkmcnt(5)
    v_mfma_f32_32x32x16_bf16 v[64:79], v[40:43], v[152:155], v[64:79]
    ds_read_b128 v[32:35], v116 offset:256
    v_subrev_u32 v116, 131072, v116
    s_waitcnt lgkmcnt(5)
    v_mfma_f32_32x32x16_bf16 v[64:79], v[44:47], v[156:159], v[64:79]
    ds_read_b128 v[36:39], v117 offset:256
    v_subrev_u32 v117, 131072, v117
    s_waitcnt lgkmcnt(5)
    v_mfma_f32_32x32x16_bf16 v[64:79], v[16:19], v[160:163], v[64:79]
    ds_read_b128 v[40:43], v118 offset:256
    v_subrev_u32 v118, 131072, v118
    s_waitcnt lgkmcnt(5)
    v_mfma_f32_32x32x16_bf16 v[64:79], v[20:23], v[164:167], v[64:79]
    ds_read_b128 v[44:47], v119 offset:256
    v_subrev_u32 v119, 131072, v119
    s_waitcnt lgkmcnt(5)
    v_mfma_f32_32x32x16_bf16 v[64:79], v[24:27], v[168:171], v[64:79]
    s_waitcnt lgkmcnt(4)
    v_mfma_f32_32x32x16_bf16 v[64:79], v[28:31], v[172:175], v[64:79]
    s_waitcnt lgkmcnt(3)
    v_mfma_f32_32x32x16_bf16 v[64:79], v[32:35], v[176:179], v[64:79]
    s_waitcnt lgkmcnt(2)
    v_mfma_f32_32x32x16_bf16 v[64:79], v[36:39], v[180:183], v[64:79]
    s_waitcnt lgkmcnt(1)
    v_mfma_f32_32x32x16_bf16 v[64:79], v[40:43], v[184:187], v[64:79]
    s_waitcnt lgkmcnt(0)
    v_mfma_f32_32x32x16_bf16 v[64:79], v[44:47], v[188:191], v[64:79]
    s_waitcnt vmcnt(0)
    s_mov_b64 exec, 1
    ds_add_u32 v124, v125 offset:4
    s_mov_b64 exec, -1
lw3:
    ds_read_b32 v126, v124 offset:4
    s_waitcnt lgkmcnt(0)
    v_readfirstlane_b32 s78, v126
    s_cmp_lt_u32 s78, 4
    s_cbranch_scc1 lw3
    ds_read_b128 v[16:19], v112 offset:0
    ds_read_b128 v[20:23], v113 offset:0
    ds_read_b128 v[24:27], v114 offset:0
    ds_read_b128 v[28:31], v115 offset:0
    ds_read_b128 v[32:35], v116 offset:0
    ds_read_b128 v[36:39], v117 offset:0
    s_waitcnt lgkmcnt(5)
    v_mfma_f32_32x32x16_bf16 v[80:95], v[16:19], v[128:131], 0
    ds_read_b128 v[40:43], v118 offset:0
    s_waitcnt lgkmcnt(5)
    v_mfma_f32_32x32x16_bf16 v[80:95], v[20:23], v[132:135], v[80:95]
    ds_read_b128 v[44:47], v119 offset:0
    s_waitcnt lgkmcnt(5)
    v_mfma_f32_32x32x16_bf16 v[80:95], v[24:27], v[136:139], v[80:95]
    ds_read_b128 v[16:19], v112 offset:256
    s_waitcnt lgkmcnt(5)
    v_mfma_f32_32x32x16_bf16 v[80:95], v[28:31], v[140:143], v[80:95]
    ds_read_b128 v[20:23], v113 offset:256
    s_waitcnt lgkmcnt(5)
    v_mfma_f32_32x32x16_bf16 v[80:95], v[32:35], v[144:147], v[80:95]
    ds_read_b128 v[24:27], v114 offset:256
    s_waitcnt lgkmcnt(5)
    v_mfma_f32_32x32x16_bf16 v[80:95], v[36:39], v[148:151], v[80:95]
    ds_read_b128 v[28:31], v115 offset:256
    s_waitcnt lgkmcnt(5)
    v_mfma_f32_32x32x16_bf16 v[80:95], v[40:43], v[152:155], v[80:95]
    ds_read_b128 v[32:35], v116 offset:256
    s_waitcnt lgkmcnt(5)
    v_mfma_f32_32x32x16_bf16 v[80:95], v[44:47], v[156:159], v[80:95]
    ds_read_b128 v[36:39], v117 offset:256
    s_waitcnt lgkmcnt(5)
    v_mfma_f32_32x32x16_bf16 v[80:95], v[16:19], v[160:163], v[80:95]
    ds_read_b128 v[40:43], v118 offset:256
    s_waitcnt lgkmcnt(5)
    v_mfma_f32_32x32x16_bf16 v[80:95], v[20:23], v[164:167], v[80:95]
    ds_read_b128 v[44:47], v119 offset:256
    s_waitcnt lgkmcnt(5)
    v_mfma_f32_32x32x16_bf16 v[80:95], v[24:27], v[168:171], v[80:95]
    s_waitcnt lgkmcnt(4)
    v_mfma_f32_32x32x16_bf16 v[80:95], v[28:31], v[172:175], v[80:95]
    s_waitcnt lgkmcnt(3)
    v_mfma_f32_32x32x16_bf16 v[80:95], v[32:35], v[176:179], v[80:95]
    s_waitcnt lgkmcnt(2)
    v_mfma_f32_32x32x16_bf16 v[80:95], v[36:39], v[180:183], v[80:95]
    s_waitcnt lgkmcnt(1)
    v_mfma_f32_32x32x16_bf16 v[80:95], v[40:43], v[184:187], v[80:95]
    s_waitcnt lgkmcnt(0)
    v_mfma_f32_32x32x16_bf16 v[80:95], v[44:47], v[188:191], v[80:95]
    s_and_b32 s9, s60, 1
    s_lshl_b32 s9, s9, 12
    s_lshr_b32 s10, s60, 1
    s_lshl_b32 s11, s10, 11
    s_add_u32 s9, s9, s11
    s_add_u32 s9, s9, 86016
    v_add_u32 v2, s9, v14
    s_lshl_b32 s12, s60, 10
    s_add_u32 s12, s12, 81920
    v_add_u32 v1, s12, v14
    s_nop 1
    v_fmac_f32 v64, v80, v15
    v_fmac_f32 v65, v81, v15
    v_fmac_f32 v66, v82, v15
    v_fmac_f32 v67, v83, v15
    v_fmac_f32 v68, v84, v15
    v_fmac_f32 v69, v85, v15
    v_fmac_f32 v70, v86, v15
    v_fmac_f32 v71, v87, v15
    v_fmac_f32 v72, v88, v15
    v_fmac_f32 v73, v89, v15
    v_fmac_f32 v74, v90, v15
    v_fmac_f32 v75, v91, v15
    v_fmac_f32 v76, v92, v15
    v_fmac_f32 v77, v93, v15
    v_fmac_f32 v78, v94, v15
    v_fmac_f32 v79, v95, v15
    v_cvt_pk_bf16_f32 v32, v64, v65
    v_cvt_pk_bf16_f32 v33, v66, v67
    v_cvt_pk_bf16_f32 v34, v68, v69
    v_cvt_pk_bf16_f32 v35, v70, v71
    v_cvt_pk_bf16_f32 v36, v72, v73
    v_cvt_pk_bf16_f32 v37, v74, v75
    v_cvt_pk_bf16_f32 v38, v76, v77
    v_cvt_pk_bf16_f32 v39, v78, v79
    ds_write_b128 v2, v[32:35]
    ds_write_b128 v2, v[36:39] offset:1024
    s_mov_b64 exec, 1
    ds_add_u32 v124, v125 offset:8
    s_mov_b64 exec, -1
    v_mov_b32 v5, 0
    v_dot2c_f32_bf16 v5, v48, v56
    v_dot2c_f32_bf16 v5, v49, v57
    v_dot2c_f32_bf16 v5, v50, v58
    v_dot2c_f32_bf16 v5, v51, v59
    v_dot2c_f32_bf16 v5, v52, v60
    v_dot2c_f32_bf16 v5, v53, v61
    v_dot2c_f32_bf16 v5, v54, v62
    v_dot2c_f32_bf16 v5, v55, v63
    v_lshrrev_b32 v6, 5, v0
    v_add_u32 v6, s76, v6
    v_and_b32 v7, 15, v6
    v_add_f32_dpp v5, v5, v5 quad_perm:[1,0,3,2] row_mask:0xf bank_mask:0xf
    v_lshrrev_b32 v6, 4, v6
    v_lshlrev_b32 v7, 9, v7
    v_add_f32_dpp v5, v5, v5 quad_perm:[2,3,0,1] row_mask:0xf bank_mask:0xf
    v_lshl_add_u32 v6, v6, 2, v7
    s_nop 0
    v_add_f32_dpp v5, v5, v5 row_half_mirror row_mask:0xf bank_mask:0xf
    s_nop 1
    v_add_f32_dpp v5, v5, v5 row_mirror row_mask:0xf bank_mask:0xf
    s_nop 1
    v_add_f32_dpp v5, v5, v5 row_bcast:15 row_mask:0xa bank_mask:0xf
    v_mul_f32 v5, 0xbfb8aa3b, v5
    v_exp_f32 v5, v5
    s_nop 0
    v_add_f32 v5, 1.0, v5
    v_rcp_f32 v5, v5
    s_mov_b32 exec_lo, 0x80000000
    s_mov_b32 exec_hi, 0x80000000
    s_mov_b32 s76, 10485760
    buffer_store_dword v5, v6, s[48:51], s76 offen sc1
    s_mov_b64 exec, -1
    v_mov_b32 v28, 98048
    v_mov_b64 v[112:113], 0
    v_mov_b64 v[114:115], 0
    v_mov_b64 v[116:117], 0
    v_mov_b64 v[118:119], 0
    v_mov_b64 v[120:121], 0
    v_mov_b64 v[122:123], 0
    v_mov_b64 v[124:125], 0
    v_mov_b64 v[126:127], 0
lw4:
    ds_read_b32 v30, v28 offset:12
    s_waitcnt lgkmcnt(0)
    v_readfirstlane_b32 s78, v30
    s_cmp_lt_u32 s78, 4
    s_cbranch_scc1 lw4
    ds_read_b128 v[20:23], v1
    s_branch att_body2
gated_mix__spectral_fnet__sliding_block__prompt_kernel_end:
    s_endpgm
.section .rodata,"a"
.p2align 6
.amdhsa_kernel gated_mix__spectral_fnet__sliding_block__prompt_kernel
  .amdhsa_next_free_vgpr 256
  .amdhsa_next_free_sgpr 102
  .amdhsa_accum_offset 256
  .amdhsa_group_segment_fixed_size 0
  .amdhsa_kernarg_size 96
  .amdhsa_user_sgpr_count 2
  .amdhsa_user_sgpr_kernarg_segment_ptr 1
  .amdhsa_system_sgpr_workgroup_id_x 1
.end_amdhsa_kernel
```
